```python
import torch

def _softmax(x, axis=-1):
    return torch.softmax(x, dim=axis)
def _gelu(x):
    return torch.nn.functional.gelu(x, approximate="tanh")
def _silu(x):
    return torch.nn.functional.silu(x)
def _sigmoid(x):
    return torch.sigmoid(x)
def _layernorm(x, axis=-1, eps=1e-5):
    m = x.mean(dim=axis, keepdim=True)
    v = x.var(dim=axis, keepdim=True, unbiased=False)
    return (x - m) / torch.sqrt(v + eps)
def _scatter_add(tgt, idx, src, axis=0):
    return tgt.clone().index_add_(axis, idx, src)
def _segment_sum(src, seg, n):
    out = torch.zeros((n,) + src.shape[1:], dtype=src.dtype)
    return out.index_add_(0, seg, src)
def _pad(x, pw):
    flat = tuple(v for pair in reversed(pw) for v in pair)
    return torch.nn.functional.pad(x, flat)

kernel_name = 'gated_mix__ssm_conv_h3__grouped_kv_mqa__prompt'

def setup_inputs():

    _w = (lambda a: (lambda t: t.to(torch.bfloat16) if t.is_floating_point() else t)(torch.as_tensor(a)))
    def _A_setup():
        B, S, D = 1, 2048, 640
        ks = 4
        return {
            "q": _w((lambda *s: torch.randn(*s, dtype=torch.bfloat16) * 0.05)(B, S, D)),
            "k": _w((lambda *s: torch.randn(*s, dtype=torch.bfloat16) * 0.2)(B, S, D)),
            "v": _w((lambda *s: torch.randn(*s, dtype=torch.bfloat16) * 0.2)(B, S, D)),
            "shift_k": _w((lambda *s: torch.randn(*s, dtype=torch.bfloat16) * 0.2)(D, ks) * 0.5),
            "ssm_k": _w((lambda *s: torch.randn(*s, dtype=torch.bfloat16) * 0.8)(D, S) * (1.0 / S ** 0.5)),
            "ssm_D": _w((lambda *s: torch.randn(*s, dtype=torch.bfloat16) * 0.2)(D)),
        }
    _A_in = _A_setup()

    def _B_setup():
        B, S, D, H = 1, 2048, 640, 32
        Dh = D // H
        return {
            "x": _w((lambda *s: torch.randn(*s, dtype=torch.bfloat16) * 0.05)(B, S, D)),
            "wq": _w((lambda *s: torch.randn(*s, dtype=torch.bfloat16) * 0.8)(D, H * Dh)),
            "wk": _w((lambda *s: torch.randn(*s, dtype=torch.bfloat16) * 0.8)(D, Dh)),
            "wv": _w((lambda *s: torch.randn(*s, dtype=torch.bfloat16) * 0.05)(D, Dh)),
            "wo": _w((lambda *s: torch.randn(*s, dtype=torch.bfloat16) * 0.05)(H * Dh, D)),
        }
    _B_in = _B_setup()

    return {
        "A_q": _A_in["q"],
        "A_k": _A_in["k"],
        "A_v": _A_in["v"],
        "A_shift_k": _A_in["shift_k"],
        "A_ssm_k": _A_in["ssm_k"],
        "A_ssm_D": _A_in["ssm_D"],
        "B_x": _B_in["x"],
        "B_wq": _B_in["wq"],
        "B_wk": _B_in["wk"],
        "B_wv": _B_in["wv"],
        "B_wo": _B_in["wo"],
        "gate_w": _w((lambda *s: torch.randn(*s, dtype=torch.bfloat16) * 0.05)(640) * 16.0),
    }

def reference(A_q, A_k, A_v, A_shift_k, A_ssm_k, A_ssm_D, B_x, B_wq, B_wk, B_wv, B_wo, gate_w):
    def _A_ref(q, k, v, shift_k, ssm_k, ssm_D):
        B, S, D = q.shape
        ks = shift_k.shape[-1]
        k_pad = _pad(k, ((0, 0), (ks - 1, 0), (0, 0)))
        k_shift = torch.zeros_like(k)
        for t in range(ks):
            k_shift = k_shift + k_pad[:, t:t + S, :] * shift_k[:, ks - 1 - t][None, None, :]
        kv = k_shift * v
        L = 2 * S
        kv_pad = _pad(kv, ((0, 0), (0, S), (0, 0)))
        kf_pad = _pad(ssm_k, ((0, 0), (0, S)))
        kv_f = (lambda x, axes=(-2,-1): torch.fft.rfft2(x.float(), dim=axes))(kv_pad[:, None, :, :], axes=(1, 2))
        kf_f = (lambda x, axes=(-2,-1): torch.fft.rfft2(x.float(), dim=axes))(kf_pad[:, None, :], axes=(1, 2))
        kf_f = (lambda x, *d: x.permute(*d))(kf_f, 1, 2, 0)
        y_f = kv_f * kf_f[None, :, :, :]
        y = (lambda x, s, axes=(-2,-1): torch.fft.irfft2(x, s=s, dim=axes).to(torch.bfloat16))(y_f, (1, L), axes=(1, 2))[:, 0, :S, :]
        y = y + kv * ssm_D[None, None, :]
        return q * y

    def _B_ref(x, wq, wk, wv, wo):
        B, S, D = x.shape
        H = 32
        Dh = D // H
        q = (lambda x, *d: x.permute(*d))((x @ wq).reshape(B, S, H, Dh), 0, 2, 1, 3)
        k = x @ wk
        v = x @ wv
        scores = torch.einsum("bhqd,bkd->bhqk", q, k) * (Dh ** -0.5)
        p = _softmax(scores, axis=-1)
        o = torch.einsum("bhqk,bkd->bhqd", p, v)
        return (lambda x, *d: x.permute(*d))(o, 0, 2, 1, 3).reshape(B, S, H * Dh) @ wo

    x = A_q
    g = _sigmoid((x * gate_w).sum(-1, keepdims=True))
    a = _A_ref(x, A_k, A_v, A_shift_k, A_ssm_k, A_ssm_D)
    b = _B_ref(x, B_wq, B_wk, B_wv, B_wo)
    return g * a + (1 - g) * b
```

```asm
; @launch grid=(256,1,1) block=(768,1,1) lds=163840
.amdgcn_target "amdgcn-amd-amdhsa--gfx950"
.text
.globl gated_mix__ssm_conv_h3__grouped_kv_mqa__prompt_kernel
.p2align 8
.type gated_mix__ssm_conv_h3__grouped_kv_mqa__prompt_kernel,@function
gated_mix__ssm_conv_h3__grouped_kv_mqa__prompt_kernel:
  s_cmp_ge_u32 s2, 256
  s_cbranch_scc1 gated_mix__ssm_conv_h3__grouped_kv_mqa__prompt_kernel_end
  s_load_dwordx2 s[16:17], s[0:1], 112
  s_load_dwordx2 s[4:5], s[0:1], 0
  s_load_dwordx2 s[8:9], s[0:1], 56
  s_load_dwordx2 s[20:21], s[0:1], 8
  s_load_dwordx2 s[24:25], s[0:1], 16
  s_load_dwordx2 s[28:29], s[0:1], 24
  s_load_dwordx2 s[32:33], s[0:1], 88
  s_load_dwordx2 s[36:37], s[0:1], 80
  s_load_dwordx2 s[40:41], s[0:1], 96
  s_load_dwordx2 s[44:45], s[0:1], 32
  s_load_dwordx2 s[48:49], s[0:1], 40
  s_load_dwordx4 s[80:83], s[0:1], 64
  s_and_b32 s3, s2, 7
  s_lshl_b32 s3, s3, 2
  s_lshr_b32 s56, s2, 3
  s_and_b32 s56, s56, 3
  s_add_u32 s56, s56, s3
  s_lshr_b32 s57, s2, 5
  v_and_b32 v1, 63, v0
  v_lshrrev_b32 v4, 6, v0
  s_nop 0
  v_readfirstlane_b32 s58, v4
  s_mov_b32 s6, 2621440
  s_mov_b32 s7, 0x20000
  s_mov_b32 s10, 819200
  s_mov_b32 s11, 0x20000
  s_mov_b32 s18, 268435456
  s_mov_b32 s19, 0x20000
  s_mov_b32 s22, 2621440
  s_mov_b32 s23, 0x20000
  s_mov_b32 s26, 2621440
  s_mov_b32 s27, 0x20000
  s_mov_b32 s30, 5120
  s_mov_b32 s31, 0x20000
  s_mov_b32 s34, 1280
  s_mov_b32 s35, 0x20000
  s_mov_b32 s38, 819200
  s_mov_b32 s39, 0x20000
  s_mov_b32 s42, 2621440
  s_mov_b32 s43, 0x20000
  s_mov_b32 s46, 2621440
  s_mov_b32 s47, 0x20000
  s_mov_b32 s50, 1280
  s_mov_b32 s51, 0x20000
  s_mov_b32 s14, 25600
  s_mov_b32 s15, 0x20000
  s_cmp_ge_u32 s58, 11
  s_cbranch_scc1 gated_mix__ssm_conv_h3__grouped_kv_mqa__prompt_kernel_loader
  s_cmp_ge_u32 s58, 8
  s_cbranch_scc1 gated_mix__ssm_conv_h3__grouped_kv_mqa__prompt_kernel_aux
  v_and_b32 v2, 15, v0
  v_bfe_u32 v3, v0, 4, 2
  s_and_b32 s59, s58, 3
  s_lshr_b32 s65, s58, 2
  v_lshrrev_b32 v13, 3, v1
  v_lshrrev_b32 v14, 1, v13
  s_lshl_b32 s60, s65, 2
  v_add_u32 v14, s60, v14
  v_and_b32 v15, 7, v1
  v_xor_b32 v15, v15, v14
  v_lshlrev_b32 v15, 4, v15
  v_mul_u32_u24 v13, 1280, v13
  v_add_u32 v4, v13, v15
  s_lshl_b32 s61, s59, 1
  s_add_u32 s61, s61, s65
  s_lshl_b32 s60, s56, 6
  s_lshl_b32 s62, s61, 3
  s_add_u32 s60, s60, s62
  s_mul_i32 s60, s60, 1280
  s_mul_i32 s61, s61, 10240
  s_and_b32 s62, s57, 3
  s_waitcnt lgkmcnt(0)
  s_load_dword s98, s[16:17], 0
  s_cmp_lt_u32 s57, 4
  s_cselect_b32 s12, s80, s82
  s_cselect_b32 s13, s81, s83
  s_cmp_eq_u32 s62, s59
  s_cbranch_scc1 gated_mix__ssm_conv_h3__grouped_kv_mqa__prompt_kernel_xfirst
  s_barrier
gated_mix__ssm_conv_h3__grouped_kv_mqa__prompt_kernel_xfirst:
  s_mov_b32 s66, 0
  s_lshl_b32 s67, s66, 7
  s_add_u32 s67, s67, s60
  s_lshl_b32 s68, s66, 10
  s_add_u32 m0, s68, s61
  s_add_u32 s66, s66, 1
  buffer_load_dwordx4 v4, s[4:7], s67 offen lds
  s_cmp_eq_u32 s66, 10
  s_cselect_b32 s66, 0, s66
  s_lshl_b32 s67, s66, 7
  s_add_u32 s67, s67, s60
  s_lshl_b32 s68, s66, 10
  s_add_u32 m0, s68, s61
  s_add_u32 s66, s66, 1
  buffer_load_dwordx4 v4, s[4:7], s67 offen lds
  s_cmp_eq_u32 s66, 10
  s_cselect_b32 s66, 0, s66
  s_lshl_b32 s67, s66, 7
  s_add_u32 s67, s67, s60
  s_lshl_b32 s68, s66, 10
  s_add_u32 m0, s68, s61
  s_add_u32 s66, s66, 1
  buffer_load_dwordx4 v4, s[4:7], s67 offen lds
  s_cmp_eq_u32 s66, 10
  s_cselect_b32 s66, 0, s66
  s_lshl_b32 s67, s66, 7
  s_add_u32 s67, s67, s60
  s_lshl_b32 s68, s66, 10
  s_add_u32 m0, s68, s61
  s_add_u32 s66, s66, 1
  buffer_load_dwordx4 v4, s[4:7], s67 offen lds
  s_cmp_eq_u32 s66, 10
  s_cselect_b32 s66, 0, s66
  s_lshl_b32 s67, s66, 7
  s_add_u32 s67, s67, s60
  s_lshl_b32 s68, s66, 10
  s_add_u32 m0, s68, s61
  s_add_u32 s66, s66, 1
  buffer_load_dwordx4 v4, s[4:7], s67 offen lds
  s_cmp_eq_u32 s66, 10
  s_cselect_b32 s66, 0, s66
  s_lshl_b32 s67, s66, 7
  s_add_u32 s67, s67, s60
  s_lshl_b32 s68, s66, 10
  s_add_u32 m0, s68, s61
  s_add_u32 s66, s66, 1
  buffer_load_dwordx4 v4, s[4:7], s67 offen lds
  s_cmp_eq_u32 s66, 10
  s_cselect_b32 s66, 0, s66
  s_lshl_b32 s67, s66, 7
  s_add_u32 s67, s67, s60
  s_lshl_b32 s68, s66, 10
  s_add_u32 m0, s68, s61
  s_add_u32 s66, s66, 1
  buffer_load_dwordx4 v4, s[4:7], s67 offen lds
  s_cmp_eq_u32 s66, 10
  s_cselect_b32 s66, 0, s66
  s_lshl_b32 s67, s66, 7
  s_add_u32 s67, s67, s60
  s_lshl_b32 s68, s66, 10
  s_add_u32 m0, s68, s61
  s_add_u32 s66, s66, 1
  buffer_load_dwordx4 v4, s[4:7], s67 offen lds
  s_cmp_eq_u32 s66, 10
  s_cselect_b32 s66, 0, s66
  s_lshl_b32 s67, s66, 7
  s_add_u32 s67, s67, s60
  s_lshl_b32 s68, s66, 10
  s_add_u32 m0, s68, s61
  s_add_u32 s66, s66, 1
  buffer_load_dwordx4 v4, s[4:7], s67 offen lds
  s_cmp_eq_u32 s66, 10
  s_cselect_b32 s66, 0, s66
  s_lshl_b32 s67, s66, 7
  s_add_u32 s67, s67, s60
  s_lshl_b32 s68, s66, 10
  s_add_u32 m0, s68, s61
  s_add_u32 s66, s66, 1
  buffer_load_dwordx4 v4, s[4:7], s67 offen lds
  s_cmp_eq_u32 s66, 10
  s_cselect_b32 s66, 0, s66
  s_lshl_b32 s64, s59, 2
  s_add_u32 s64, s64, 161984
  s_cmp_lg_u32 s62, s59
  s_cbranch_scc1 gated_mix__ssm_conv_h3__grouped_kv_mqa__prompt_kernel_xsecond
  s_barrier
gated_mix__ssm_conv_h3__grouped_kv_mqa__prompt_kernel_xsecond:
  s_mul_i32 s60, s57, 160
  v_add_u32 v13, 0, v1
  v_mul_u32_u24 v14, 0xAAAB, v13
  v_lshrrev_b32 v14, 19, v14
  v_mul_u32_u24 v15, 12, v14
  v_sub_u32 v15, v13, v15
  v_lshrrev_b32 v13, 3, v14
  v_lshlrev_b32 v13, 1, v13
  v_sub_u32 v15, v15, v13
  v_lshlrev_b32 v15, 4, v15
  v_mul_u32_u24 v14, 1280, v14
  v_add_u32 v14, v14, v15
  v_add_u32 v5, s60, v14
  v_add_u32 v13, 64, v1
  v_mul_u32_u24 v14, 0xAAAB, v13
  v_lshrrev_b32 v14, 19, v14
  v_mul_u32_u24 v15, 12, v14
  v_sub_u32 v15, v13, v15
  v_lshrrev_b32 v13, 3, v14
  v_lshlrev_b32 v13, 1, v13
  v_sub_u32 v15, v15, v13
  v_lshlrev_b32 v15, 4, v15
  v_mul_u32_u24 v14, 1280, v14
  v_add_u32 v14, v14, v15
  v_add_u32 v6, s60, v14
  v_add_u32 v13, 128, v1
  v_mul_u32_u24 v14, 0xAAAB, v13
  v_lshrrev_b32 v14, 19, v14
  v_mul_u32_u24 v15, 12, v14
  v_sub_u32 v15, v13, v15
  v_lshrrev_b32 v13, 3, v14
  v_lshlrev_b32 v13, 1, v13
  v_sub_u32 v15, v15, v13
  v_lshlrev_b32 v15, 4, v15
  v_mul_u32_u24 v14, 1280, v14
  v_add_u32 v14, v14, v15
  v_add_u32 v7, s60, v14
  s_mov_b32 s80, 0
  s_add_u32 s62, s58, 0
  s_mul_i32 s61, s62, 3072
  s_add_u32 s61, s61, 81920
  s_and_b32 s67, s62, 1
  s_lshr_b32 s62, s62, 1
  s_add_u32 s60, s62, s80
  s_sub_u32 s68, s60, 20
  s_cmp_ge_u32 s60, 20
  s_cselect_b32 s60, s68, s60
  s_lshl_b32 s60, s60, 1
  s_add_u32 s60, s60, s67
  s_mul_i32 s60, s60, 20480
  s_mov_b32 m0, s61
  s_nop 0
  buffer_load_dwordx4 v5, s[8:11], s60 offen lds
  s_add_u32 m0, s61, 1024
  s_nop 0
  buffer_load_dwordx4 v6, s[8:11], s60 offen lds
  s_add_u32 m0, s61, 2048
  s_nop 0
  buffer_load_dwordx4 v7, s[8:11], s60 offen lds
  s_add_u32 s62, s58, 8
  s_mul_i32 s61, s62, 3072
  s_add_u32 s61, s61, 81920
  s_and_b32 s67, s62, 1
  s_lshr_b32 s62, s62, 1
  s_add_u32 s60, s62, s80
  s_sub_u32 s68, s60, 20
  s_cmp_ge_u32 s60, 20
  s_cselect_b32 s60, s68, s60
  s_lshl_b32 s60, s60, 1
  s_add_u32 s60, s60, s67
  s_mul_i32 s60, s60, 20480
  s_mov_b32 m0, s61
  s_nop 0
  buffer_load_dwordx4 v5, s[8:11], s60 offen lds
  s_add_u32 m0, s61, 1024
  s_nop 0
  buffer_load_dwordx4 v6, s[8:11], s60 offen lds
  s_add_u32 m0, s61, 2048
  s_nop 0
  buffer_load_dwordx4 v7, s[8:11], s60 offen lds
  s_mul_i32 s62, s59, 6
  s_add_u32 s62, s62, s65
  s_add_u32 s62, s62, 16
  s_mul_i32 s60, s62, 20480
  buffer_load_dwordx4 v[40:43], v5, s[8:11], s60 offen
  buffer_load_dwordx4 v[44:47], v6, s[8:11], s60 offen
  buffer_load_dwordx4 v[48:51], v7, s[8:11], s60 offen
  s_mul_i32 s62, s59, 6
  s_add_u32 s62, s62, s65
  s_add_u32 s62, s62, 18
  s_mul_i32 s60, s62, 20480
  buffer_load_dwordx4 v[52:55], v5, s[8:11], s60 offen
  buffer_load_dwordx4 v[56:59], v6, s[8:11], s60 offen
  buffer_load_dwordx4 v[60:63], v7, s[8:11], s60 offen
  s_mul_i32 s62, s59, 6
  s_add_u32 s62, s62, s65
  s_add_u32 s62, s62, 20
  s_mul_i32 s60, s62, 20480
  buffer_load_dwordx4 v[156:159], v5, s[8:11], s60 offen
  buffer_load_dwordx4 v[160:163], v6, s[8:11], s60 offen
  buffer_load_dwordx4 v[164:167], v7, s[8:11], s60 offen
  v_mov_b32 v10, 162076
  v_mov_b32 v11, 1
  s_mov_b64 exec, 1
  ds_add_u32 v10, v11
  s_mov_b64 exec, -1
  v_lshrrev_b32 v13, 2, v2
  v_lshl_add_u32 v13, v3, 3, v13
  v_mul_u32_u24 v8, 192, v13
  v_and_b32 v13, 1, v3
  v_lshl_add_u32 v8, v13, 5, v8
  v_and_b32 v13, 3, v1
  v_lshl_add_u32 v8, v13, 3, v8
  v_add_u32 v9, 61440, v8
  v_lshrrev_b32 v13, 3, v2
  s_lshl_b32 s60, s59, 1
  v_add_u32 v13, s60, v13
  v_mul_u32_u24 v13, 10240, v13
  v_and_b32 v14, 7, v2
  v_lshl_add_u32 v13, v14, 7, v13
  v_bfe_u32 v14, v2, 1, 3
  v_xor_b32 v15, v3, v14
  v_lshl_add_u32 v4, v15, 4, v13
  v_add_u32 v15, 4, v3
  v_xor_b32 v15, v15, v14
  v_lshl_add_u32 v12, v15, 4, v13
  v_mov_b32 v144, 0
  v_mov_b32 v145, 0
  v_mov_b32 v146, 0
  v_mov_b32 v147, 0
  v_mov_b32 v148, 0
  v_mov_b32 v149, 0
  v_mov_b32 v150, 0
  v_mov_b32 v151, 0
  v_mov_b32 v152, 0
  v_mov_b32 v153, 0
  v_mov_b32 v154, 0
  v_mov_b32 v155, 0
  s_waitcnt vmcnt(15)
  v_mov_b32 v10, s64
  v_mov_b32 v11, 1
  s_mov_b64 exec, 1
  ds_add_u32 v10, v11
  s_mov_b64 exec, -1
  v_mov_b32 v10, s64
  s_mov_b32 s63, 0
gated_mix__ssm_conv_h3__grouped_kv_mqa__prompt_kernel_xlsp:
  ds_read_b32 v11, v10
  s_waitcnt lgkmcnt(0)
  v_readfirstlane_b32 s69, v11
  s_nop 3
  s_cmp_ge_u32 s69, 2
  s_cbranch_scc1 gated_mix__ssm_conv_h3__grouped_kv_mqa__prompt_kernel_xlsp_ok
  s_add_u32 s63, s63, 1
  s_cmp_gt_u32 s63, 1000000
  s_cbranch_scc1 gated_mix__ssm_conv_h3__grouped_kv_mqa__prompt_kernel_exit
  s_branch gated_mix__ssm_conv_h3__grouped_kv_mqa__prompt_kernel_xlsp
gated_mix__ssm_conv_h3__grouped_kv_mqa__prompt_kernel_xlsp_ok:
  s_cmp_lg_u32 s80, 0
  s_cbranch_scc1 gated_mix__ssm_conv_h3__grouped_kv_mqa__prompt_kernel_xr1
  ds_read_b128 v[64:67], v4 offset:0
  ds_read_b128 v[68:71], v12 offset:0
  ds_read_b128 v[72:75], v4 offset:1024
  ds_read_b128 v[76:79], v12 offset:1024
  ds_read_b128 v[80:83], v4 offset:2048
  ds_read_b128 v[84:87], v12 offset:2048
  ds_read_b128 v[88:91], v4 offset:3072
  ds_read_b128 v[92:95], v12 offset:3072
  ds_read_b128 v[96:99], v4 offset:4096
  ds_read_b128 v[100:103], v12 offset:4096
  ds_read_b128 v[104:107], v4 offset:5120
  ds_read_b128 v[108:111], v12 offset:5120
  ds_read_b128 v[112:115], v4 offset:6144
  ds_read_b128 v[116:119], v12 offset:6144
  ds_read_b128 v[120:123], v4 offset:7168
  ds_read_b128 v[124:127], v12 offset:7168
  ds_read_b128 v[128:131], v4 offset:8192
  ds_read_b128 v[132:135], v12 offset:8192
  ds_read_b128 v[136:139], v4 offset:9216
  ds_read_b128 v[140:143], v12 offset:9216
  s_branch gated_mix__ssm_conv_h3__grouped_kv_mqa__prompt_kernel_xrd
gated_mix__ssm_conv_h3__grouped_kv_mqa__prompt_kernel_xr1:
  s_cmp_lg_u32 s80, 5
  s_cbranch_scc1 gated_mix__ssm_conv_h3__grouped_kv_mqa__prompt_kernel_xr2
  ds_read_b128 v[64:67], v12 offset:2048
  ds_read_b128 v[68:71], v4 offset:3072
  ds_read_b128 v[72:75], v12 offset:3072
  ds_read_b128 v[76:79], v4 offset:4096
  ds_read_b128 v[80:83], v12 offset:4096
  ds_read_b128 v[84:87], v4 offset:5120
  ds_read_b128 v[88:91], v12 offset:5120
  ds_read_b128 v[92:95], v4 offset:6144
  ds_read_b128 v[96:99], v12 offset:6144
  ds_read_b128 v[100:103], v4 offset:7168
  ds_read_b128 v[104:107], v12 offset:7168
  ds_read_b128 v[108:111], v4 offset:8192
  ds_read_b128 v[112:115], v12 offset:8192
  ds_read_b128 v[116:119], v4 offset:9216
  ds_read_b128 v[120:123], v12 offset:9216
  ds_read_b128 v[124:127], v4 offset:0
  ds_read_b128 v[128:131], v12 offset:0
  ds_read_b128 v[132:135], v4 offset:1024
  ds_read_b128 v[136:139], v12 offset:1024
  ds_read_b128 v[140:143], v4 offset:2048
  s_branch gated_mix__ssm_conv_h3__grouped_kv_mqa__prompt_kernel_xrd
gated_mix__ssm_conv_h3__grouped_kv_mqa__prompt_kernel_xr2:
  s_cmp_lg_u32 s80, 10
  s_cbranch_scc1 gated_mix__ssm_conv_h3__grouped_kv_mqa__prompt_kernel_xr3
  ds_read_b128 v[64:67], v4 offset:5120
  ds_read_b128 v[68:71], v12 offset:5120
  ds_read_b128 v[72:75], v4 offset:6144
  ds_read_b128 v[76:79], v12 offset:6144
  ds_read_b128 v[80:83], v4 offset:7168
  ds_read_b128 v[84:87], v12 offset:7168
  ds_read_b128 v[88:91], v4 offset:8192
  ds_read_b128 v[92:95], v12 offset:8192
  ds_read_b128 v[96:99], v4 offset:9216
  ds_read_b128 v[100:103], v12 offset:9216
  ds_read_b128 v[104:107], v4 offset:0
  ds_read_b128 v[108:111], v12 offset:0
  ds_read_b128 v[112:115], v4 offset:1024
  ds_read_b128 v[116:119], v12 offset:1024
  ds_read_b128 v[120:123], v4 offset:2048
  ds_read_b128 v[124:127], v12 offset:2048
  ds_read_b128 v[128:131], v4 offset:3072
  ds_read_b128 v[132:135], v12 offset:3072
  ds_read_b128 v[136:139], v4 offset:4096
  ds_read_b128 v[140:143], v12 offset:4096
  s_branch gated_mix__ssm_conv_h3__grouped_kv_mqa__prompt_kernel_xrd
gated_mix__ssm_conv_h3__grouped_kv_mqa__prompt_kernel_xr3:
  ds_read_b128 v[64:67], v12 offset:7168
  ds_read_b128 v[68:71], v4 offset:8192
  ds_read_b128 v[72:75], v12 offset:8192
  ds_read_b128 v[76:79], v4 offset:9216
  ds_read_b128 v[80:83], v12 offset:9216
  ds_read_b128 v[84:87], v4 offset:0
  ds_read_b128 v[88:91], v12 offset:0
  ds_read_b128 v[92:95], v4 offset:1024
  ds_read_b128 v[96:99], v12 offset:1024
  ds_read_b128 v[100:103], v4 offset:2048
  ds_read_b128 v[104:107], v12 offset:2048
  ds_read_b128 v[108:111], v4 offset:3072
  ds_read_b128 v[112:115], v12 offset:3072
  ds_read_b128 v[116:119], v4 offset:4096
  ds_read_b128 v[120:123], v12 offset:4096
  ds_read_b128 v[124:127], v4 offset:5120
  ds_read_b128 v[128:131], v12 offset:5120
  ds_read_b128 v[132:135], v4 offset:6144
  ds_read_b128 v[136:139], v12 offset:6144
  ds_read_b128 v[140:143], v4 offset:7168
gated_mix__ssm_conv_h3__grouped_kv_mqa__prompt_kernel_xrd:
  s_waitcnt lgkmcnt(0)
  s_add_u32 s98, s98, 1
  s_add_u32 s64, s64, 16
  v_mov_b32 v10, s64
  v_mov_b32 v11, 1
  s_mov_b64 exec, 1
  ds_add_u32 v10, v11
  s_mov_b64 exec, -1
  s_cmp_lt_u32 s58, 4
  s_cbranch_scc1 gated_mix__ssm_conv_h3__grouped_kv_mqa__prompt_kernel_g3
  s_branch gated_mix__ssm_conv_h3__grouped_kv_mqa__prompt_kernel_g2
gated_mix__ssm_conv_h3__grouped_kv_mqa__prompt_kernel_g3:
  s_waitcnt vmcnt(9)
  v_mov_b32 v10, 162016
  v_mov_b32 v11, 1
  s_mov_b64 exec, 1
  ds_add_u32 v10, v11
  s_mov_b64 exec, -1
  v_mov_b32 v10, 162016
  s_mov_b32 s63, 0
gated_mix__ssm_conv_h3__grouped_kv_mqa__prompt_kernel_wa0:
  ds_read_b32 v11, v10
  s_waitcnt lgkmcnt(0)
  v_readfirstlane_b32 s69, v11
  s_nop 3
  s_cmp_ge_u32 s69, 8
  s_cbranch_scc1 gated_mix__ssm_conv_h3__grouped_kv_mqa__prompt_kernel_wa0_ok
  s_add_u32 s63, s63, 1
  s_cmp_gt_u32 s63, 1000000
  s_cbranch_scc1 gated_mix__ssm_conv_h3__grouped_kv_mqa__prompt_kernel_exit
  s_branch gated_mix__ssm_conv_h3__grouped_kv_mqa__prompt_kernel_wa0
gated_mix__ssm_conv_h3__grouped_kv_mqa__prompt_kernel_wa0_ok:
  ds_read_b64_tr_b16 v[16:17], v9 offset:20480
  ds_read_b64_tr_b16 v[18:19], v9 offset:21248
  ds_read_b64_tr_b16 v[20:21], v9 offset:20512
  ds_read_b64_tr_b16 v[22:23], v9 offset:21280
  ds_read_b64_tr_b16 v[24:25], v9 offset:20544
  ds_read_b64_tr_b16 v[26:27], v9 offset:21312
  ds_read_b64_tr_b16 v[28:29], v9 offset:26624
  ds_read_b64_tr_b16 v[30:31], v9 offset:27392
  ds_read_b64_tr_b16 v[32:33], v9 offset:26656
  ds_read_b64_tr_b16 v[34:35], v9 offset:27424
  ds_read_b64_tr_b16 v[36:37], v9 offset:26688
  ds_read_b64_tr_b16 v[38:39], v9 offset:27456
  s_waitcnt lgkmcnt(6)
  v_mfma_f32_16x16x32_bf16 v[144:147], v[16:19], v[64:67], v[144:147]
  v_mfma_f32_16x16x32_bf16 v[148:151], v[20:23], v[64:67], v[148:151]
  v_mfma_f32_16x16x32_bf16 v[152:155], v[24:27], v[64:67], v[152:155]
  ds_read_b64_tr_b16 v[16:17], v9 offset:32768
  ds_read_b64_tr_b16 v[18:19], v9 offset:33536
  ds_read_b64_tr_b16 v[20:21], v9 offset:32800
  ds_read_b64_tr_b16 v[22:23], v9 offset:33568
  ds_read_b64_tr_b16 v[24:25], v9 offset:32832
  ds_read_b64_tr_b16 v[26:27], v9 offset:33600
  s_waitcnt lgkmcnt(6)
  v_mfma_f32_16x16x32_bf16 v[144:147], v[28:31], v[68:71], v[144:147]
  v_mfma_f32_16x16x32_bf16 v[148:151], v[32:35], v[68:71], v[148:151]
  v_mfma_f32_16x16x32_bf16 v[152:155], v[36:39], v[68:71], v[152:155]
  ds_read_b64_tr_b16 v[28:29], v9 offset:38912
  ds_read_b64_tr_b16 v[30:31], v9 offset:39680
  ds_read_b64_tr_b16 v[32:33], v9 offset:38944
  ds_read_b64_tr_b16 v[34:35], v9 offset:39712
  ds_read_b64_tr_b16 v[36:37], v9 offset:38976
  ds_read_b64_tr_b16 v[38:39], v9 offset:39744
  s_waitcnt lgkmcnt(6)
  v_mfma_f32_16x16x32_bf16 v[144:147], v[16:19], v[72:75], v[144:147]
  v_mfma_f32_16x16x32_bf16 v[148:151], v[20:23], v[72:75], v[148:151]
  v_mfma_f32_16x16x32_bf16 v[152:155], v[24:27], v[72:75], v[152:155]
  ds_read_b64_tr_b16 v[16:17], v9 offset:45056
  ds_read_b64_tr_b16 v[18:19], v9 offset:45824
  ds_read_b64_tr_b16 v[20:21], v9 offset:45088
  ds_read_b64_tr_b16 v[22:23], v9 offset:45856
  ds_read_b64_tr_b16 v[24:25], v9 offset:45120
  ds_read_b64_tr_b16 v[26:27], v9 offset:45888
  s_waitcnt lgkmcnt(6)
  v_mfma_f32_16x16x32_bf16 v[144:147], v[28:31], v[76:79], v[144:147]
  v_mfma_f32_16x16x32_bf16 v[148:151], v[32:35], v[76:79], v[148:151]
  v_mfma_f32_16x16x32_bf16 v[152:155], v[36:39], v[76:79], v[152:155]
  ds_read_b64_tr_b16 v[28:29], v9 offset:51200
  ds_read_b64_tr_b16 v[30:31], v9 offset:51968
  ds_read_b64_tr_b16 v[32:33], v9 offset:51232
  ds_read_b64_tr_b16 v[34:35], v9 offset:52000
  ds_read_b64_tr_b16 v[36:37], v9 offset:51264
  ds_read_b64_tr_b16 v[38:39], v9 offset:52032
  s_waitcnt lgkmcnt(6)
  v_mfma_f32_16x16x32_bf16 v[144:147], v[16:19], v[80:83], v[144:147]
  v_mfma_f32_16x16x32_bf16 v[148:151], v[20:23], v[80:83], v[148:151]
  v_mfma_f32_16x16x32_bf16 v[152:155], v[24:27], v[80:83], v[152:155]
  ds_read_b64_tr_b16 v[16:17], v9 offset:57344
  ds_read_b64_tr_b16 v[18:19], v9 offset:58112
  ds_read_b64_tr_b16 v[20:21], v9 offset:57376
  ds_read_b64_tr_b16 v[22:23], v9 offset:58144
  ds_read_b64_tr_b16 v[24:25], v9 offset:57408
  ds_read_b64_tr_b16 v[26:27], v9 offset:58176
  s_waitcnt lgkmcnt(6)
  v_mfma_f32_16x16x32_bf16 v[144:147], v[28:31], v[84:87], v[144:147]
  v_mfma_f32_16x16x32_bf16 v[148:151], v[32:35], v[84:87], v[148:151]
  v_mfma_f32_16x16x32_bf16 v[152:155], v[36:39], v[84:87], v[152:155]
  ds_read_b64_tr_b16 v[28:29], v9 offset:63488
  ds_read_b64_tr_b16 v[30:31], v9 offset:64256
  ds_read_b64_tr_b16 v[32:33], v9 offset:63520
  ds_read_b64_tr_b16 v[34:35], v9 offset:64288
  ds_read_b64_tr_b16 v[36:37], v9 offset:63552
  ds_read_b64_tr_b16 v[38:39], v9 offset:64320
  s_waitcnt lgkmcnt(6)
  v_mfma_f32_16x16x32_bf16 v[144:147], v[16:19], v[88:91], v[144:147]
  v_mfma_f32_16x16x32_bf16 v[148:151], v[20:23], v[88:91], v[148:151]
  v_mfma_f32_16x16x32_bf16 v[152:155], v[24:27], v[88:91], v[152:155]
  s_waitcnt lgkmcnt(0)
  v_mfma_f32_16x16x32_bf16 v[144:147], v[28:31], v[92:95], v[144:147]
  v_mfma_f32_16x16x32_bf16 v[148:151], v[32:35], v[92:95], v[148:151]
  v_mfma_f32_16x16x32_bf16 v[152:155], v[36:39], v[92:95], v[152:155]
  v_mov_b32 v10, 162052
  v_mov_b32 v11, 1
  s_mov_b64 exec, 1
  ds_add_u32 v10, v11
  s_mov_b64 exec, -1
  s_lshl_b32 s64, s59, 2
  s_add_u32 s64, s64, 162000
  s_and_b32 s62, s57, 3
  s_cmp_eq_u32 s62, s59
  s_cselect_b32 s66, 4, 2
  v_mov_b32 v10, s64
  s_mov_b32 s63, 0
gated_mix__ssm_conv_h3__grouped_kv_mqa__prompt_kernel_xra:
  ds_read_b32 v11, v10
  s_waitcnt lgkmcnt(0)
  v_readfirstlane_b32 s69, v11
  s_nop 3
  s_cmp_ge_u32 s69, s66
  s_cbranch_scc1 gated_mix__ssm_conv_h3__grouped_kv_mqa__prompt_kernel_xra_ok
  s_add_u32 s63, s63, 1
  s_cmp_gt_u32 s63, 1000000
  s_cbranch_scc1 gated_mix__ssm_conv_h3__grouped_kv_mqa__prompt_kernel_exit
  s_branch gated_mix__ssm_conv_h3__grouped_kv_mqa__prompt_kernel_xra
gated_mix__ssm_conv_h3__grouped_kv_mqa__prompt_kernel_xra_ok:
  s_mul_i32 s60, s59, 20480
  s_mul_i32 s61, s65, 3072
  s_add_u32 s60, s60, s61
  v_lshlrev_b32 v13, 4, v1
  v_add_u32 v13, s60, v13
  s_waitcnt vmcnt(0)
  ds_write_b128 v13, v[40:43] offset:0
  ds_write_b128 v13, v[44:47] offset:1024
  ds_write_b128 v13, v[48:51] offset:2048
  ds_write_b128 v13, v[52:55] offset:6144
  ds_write_b128 v13, v[56:59] offset:7168
  ds_write_b128 v13, v[60:63] offset:8192
  ds_write_b128 v13, v[156:159] offset:12288
  ds_write_b128 v13, v[160:163] offset:13312
  ds_write_b128 v13, v[164:167] offset:14336
  s_waitcnt lgkmcnt(0)
  v_mov_b32 v10, 162020
  v_mov_b32 v11, 1
  s_mov_b64 exec, 1
  ds_add_u32 v10, v11
  s_mov_b64 exec, -1
  v_mov_b32 v10, 162020
  s_mov_b32 s63, 0
gated_mix__ssm_conv_h3__grouped_kv_mqa__prompt_kernel_wa1:
  ds_read_b32 v11, v10
  s_waitcnt lgkmcnt(0)
  v_readfirstlane_b32 s69, v11
  s_nop 3
  s_cmp_ge_u32 s69, 8
  s_cbranch_scc1 gated_mix__ssm_conv_h3__grouped_kv_mqa__prompt_kernel_wa1_ok
  s_add_u32 s63, s63, 1
  s_cmp_gt_u32 s63, 1000000
  s_cbranch_scc1 gated_mix__ssm_conv_h3__grouped_kv_mqa__prompt_kernel_exit
  s_branch gated_mix__ssm_conv_h3__grouped_kv_mqa__prompt_kernel_wa1
gated_mix__ssm_conv_h3__grouped_kv_mqa__prompt_kernel_wa1_ok:
  ds_read_b64_tr_b16 v[16:17], v8 offset:0
  ds_read_b64_tr_b16 v[18:19], v8 offset:768
  ds_read_b64_tr_b16 v[20:21], v8 offset:32
  ds_read_b64_tr_b16 v[22:23], v8 offset:800
  ds_read_b64_tr_b16 v[24:25], v8 offset:64
  ds_read_b64_tr_b16 v[26:27], v8 offset:832
  ds_read_b64_tr_b16 v[28:29], v8 offset:6144
  ds_read_b64_tr_b16 v[30:31], v8 offset:6912
  ds_read_b64_tr_b16 v[32:33], v8 offset:6176
  ds_read_b64_tr_b16 v[34:35], v8 offset:6944
  ds_read_b64_tr_b16 v[36:37], v8 offset:6208
  ds_read_b64_tr_b16 v[38:39], v8 offset:6976
  ds_read_b64_tr_b16 v[40:41], v8 offset:12288
  ds_read_b64_tr_b16 v[42:43], v8 offset:13056
  ds_read_b64_tr_b16 v[44:45], v8 offset:12320
  ds_read_b64_tr_b16 v[46:47], v8 offset:13088
  ds_read_b64_tr_b16 v[48:49], v8 offset:12352
  ds_read_b64_tr_b16 v[50:51], v8 offset:13120
  s_waitcnt lgkmcnt(12)
  v_mfma_f32_16x16x32_bf16 v[144:147], v[16:19], v[96:99], v[144:147]
  ds_read_b64_tr_b16 v[52:53], v8 offset:20480
  ds_read_b64_tr_b16 v[54:55], v8 offset:21248
  v_mfma_f32_16x16x32_bf16 v[148:151], v[20:23], v[96:99], v[148:151]
  ds_read_b64_tr_b16 v[56:57], v8 offset:20512
  ds_read_b64_tr_b16 v[58:59], v8 offset:21280
  v_mfma_f32_16x16x32_bf16 v[152:155], v[24:27], v[96:99], v[152:155]
  ds_read_b64_tr_b16 v[60:61], v8 offset:20544
  ds_read_b64_tr_b16 v[62:63], v8 offset:21312
  s_waitcnt lgkmcnt(12)
  v_mfma_f32_16x16x32_bf16 v[144:147], v[28:31], v[100:103], v[144:147]
  ds_read_b64_tr_b16 v[16:17], v8 offset:26624
  ds_read_b64_tr_b16 v[18:19], v8 offset:27392
  v_mfma_f32_16x16x32_bf16 v[148:151], v[32:35], v[100:103], v[148:151]
  ds_read_b64_tr_b16 v[20:21], v8 offset:26656
  ds_read_b64_tr_b16 v[22:23], v8 offset:27424
  v_mfma_f32_16x16x32_bf16 v[152:155], v[36:39], v[100:103], v[152:155]
  ds_read_b64_tr_b16 v[24:25], v8 offset:26688
  ds_read_b64_tr_b16 v[26:27], v8 offset:27456
  s_waitcnt lgkmcnt(12)
  v_mfma_f32_16x16x32_bf16 v[144:147], v[40:43], v[104:107], v[144:147]
  ds_read_b64_tr_b16 v[28:29], v8 offset:32768
  ds_read_b64_tr_b16 v[30:31], v8 offset:33536
  v_mfma_f32_16x16x32_bf16 v[148:151], v[44:47], v[104:107], v[148:151]
  ds_read_b64_tr_b16 v[32:33], v8 offset:32800
  ds_read_b64_tr_b16 v[34:35], v8 offset:33568
  v_mfma_f32_16x16x32_bf16 v[152:155], v[48:51], v[104:107], v[152:155]
  ds_read_b64_tr_b16 v[36:37], v8 offset:32832
  ds_read_b64_tr_b16 v[38:39], v8 offset:33600
  s_waitcnt lgkmcnt(12)
  v_mfma_f32_16x16x32_bf16 v[144:147], v[52:55], v[108:111], v[144:147]
  ds_read_b64_tr_b16 v[40:41], v8 offset:40960
  ds_read_b64_tr_b16 v[42:43], v8 offset:41728
  v_mfma_f32_16x16x32_bf16 v[148:151], v[56:59], v[108:111], v[148:151]
  ds_read_b64_tr_b16 v[44:45], v8 offset:40992
  ds_read_b64_tr_b16 v[46:47], v8 offset:41760
  v_mfma_f32_16x16x32_bf16 v[152:155], v[60:63], v[108:111], v[152:155]
  ds_read_b64_tr_b16 v[48:49], v8 offset:41024
  ds_read_b64_tr_b16 v[50:51], v8 offset:41792
  s_waitcnt lgkmcnt(12)
  v_mfma_f32_16x16x32_bf16 v[144:147], v[16:19], v[112:115], v[144:147]
  ds_read_b64_tr_b16 v[52:53], v8 offset:47104
  ds_read_b64_tr_b16 v[54:55], v8 offset:47872
  v_mfma_f32_16x16x32_bf16 v[148:151], v[20:23], v[112:115], v[148:151]
  ds_read_b64_tr_b16 v[56:57], v8 offset:47136
  ds_read_b64_tr_b16 v[58:59], v8 offset:47904
  v_mfma_f32_16x16x32_bf16 v[152:155], v[24:27], v[112:115], v[152:155]
  ds_read_b64_tr_b16 v[60:61], v8 offset:47168
  ds_read_b64_tr_b16 v[62:63], v8 offset:47936
  s_waitcnt lgkmcnt(12)
  v_mfma_f32_16x16x32_bf16 v[144:147], v[28:31], v[116:119], v[144:147]
  ds_read_b64_tr_b16 v[16:17], v8 offset:53248
  ds_read_b64_tr_b16 v[18:19], v8 offset:54016
  v_mfma_f32_16x16x32_bf16 v[148:151], v[32:35], v[116:119], v[148:151]
  ds_read_b64_tr_b16 v[20:21], v8 offset:53280
  ds_read_b64_tr_b16 v[22:23], v8 offset:54048
  v_mfma_f32_16x16x32_bf16 v[152:155], v[36:39], v[116:119], v[152:155]
  ds_read_b64_tr_b16 v[24:25], v8 offset:53312
  ds_read_b64_tr_b16 v[26:27], v8 offset:54080
  s_waitcnt lgkmcnt(12)
  v_mfma_f32_16x16x32_bf16 v[144:147], v[40:43], v[120:123], v[144:147]
  ds_read_b64_tr_b16 v[28:29], v8 offset:61440
  ds_read_b64_tr_b16 v[30:31], v8 offset:62208
  v_mfma_f32_16x16x32_bf16 v[148:151], v[44:47], v[120:123], v[148:151]
  ds_read_b64_tr_b16 v[32:33], v8 offset:61472
  ds_read_b64_tr_b16 v[34:35], v8 offset:62240
  v_mfma_f32_16x16x32_bf16 v[152:155], v[48:51], v[120:123], v[152:155]
  ds_read_b64_tr_b16 v[36:37], v8 offset:61504
  ds_read_b64_tr_b16 v[38:39], v8 offset:62272
  s_waitcnt lgkmcnt(12)
  v_mfma_f32_16x16x32_bf16 v[144:147], v[52:55], v[124:127], v[144:147]
  ds_read_b64_tr_b16 v[40:41], v9 offset:6144
  ds_read_b64_tr_b16 v[42:43], v9 offset:6912
  v_mfma_f32_16x16x32_bf16 v[148:151], v[56:59], v[124:127], v[148:151]
  ds_read_b64_tr_b16 v[44:45], v9 offset:6176
  ds_read_b64_tr_b16 v[46:47], v9 offset:6944
  v_mfma_f32_16x16x32_bf16 v[152:155], v[60:63], v[124:127], v[152:155]
  ds_read_b64_tr_b16 v[48:49], v9 offset:6208
  ds_read_b64_tr_b16 v[50:51], v9 offset:6976
  s_waitcnt lgkmcnt(12)
  v_mfma_f32_16x16x32_bf16 v[144:147], v[16:19], v[128:131], v[144:147]
  ds_read_b64_tr_b16 v[52:53], v9 offset:12288
  ds_read_b64_tr_b16 v[54:55], v9 offset:13056
  v_mfma_f32_16x16x32_bf16 v[148:151], v[20:23], v[128:131], v[148:151]
  ds_read_b64_tr_b16 v[56:57], v9 offset:12320
  ds_read_b64_tr_b16 v[58:59], v9 offset:13088
  v_mfma_f32_16x16x32_bf16 v[152:155], v[24:27], v[128:131], v[152:155]
  ds_read_b64_tr_b16 v[60:61], v9 offset:12352
  ds_read_b64_tr_b16 v[62:63], v9 offset:13120
  s_waitcnt lgkmcnt(12)
  v_mfma_f32_16x16x32_bf16 v[144:147], v[28:31], v[132:135], v[144:147]
  v_mfma_f32_16x16x32_bf16 v[148:151], v[32:35], v[132:135], v[148:151]
  v_mfma_f32_16x16x32_bf16 v[152:155], v[36:39], v[132:135], v[152:155]
  s_waitcnt lgkmcnt(6)
  v_mfma_f32_16x16x32_bf16 v[144:147], v[40:43], v[136:139], v[144:147]
  v_mfma_f32_16x16x32_bf16 v[148:151], v[44:47], v[136:139], v[148:151]
  v_mfma_f32_16x16x32_bf16 v[152:155], v[48:51], v[136:139], v[152:155]
  s_waitcnt lgkmcnt(0)
  v_mfma_f32_16x16x32_bf16 v[144:147], v[52:55], v[140:143], v[144:147]
  v_mfma_f32_16x16x32_bf16 v[148:151], v[56:59], v[140:143], v[148:151]
  v_mfma_f32_16x16x32_bf16 v[152:155], v[60:63], v[140:143], v[152:155]
  s_lshl_b32 s60, s59, 4
  v_add_u32 v13, s60, v2
  v_mul_u32_u24 v13, 160, v13
  v_lshl_add_u32 v13, v3, 3, v13
  v_add_u32 v13, 101376, v13
  s_mov_b32 s61, 0x3ea52b5c
  v_mul_f32 v144, s61, v144
  v_mul_f32 v145, s61, v145
  v_mul_f32 v146, s61, v146
  v_mul_f32 v147, s61, v147
  v_cvt_pk_bf16_f32 v144, v144, v145
  v_cvt_pk_bf16_f32 v145, v146, v147
  ds_write_b64 v13, v[144:145] offset:0
  v_mul_f32 v148, s61, v148
  v_mul_f32 v149, s61, v149
  v_mul_f32 v150, s61, v150
  v_mul_f32 v151, s61, v151
  v_cvt_pk_bf16_f32 v148, v148, v149
  v_cvt_pk_bf16_f32 v149, v150, v151
  ds_write_b64 v13, v[148:149] offset:32
  v_mul_f32 v152, s61, v152
  v_mul_f32 v153, s61, v153
  v_mul_f32 v154, s61, v154
  v_mul_f32 v155, s61, v155
  v_cvt_pk_bf16_f32 v152, v152, v153
  v_cvt_pk_bf16_f32 v153, v154, v155
  ds_write_b64 v13, v[152:153] offset:64
  s_branch gated_mix__ssm_conv_h3__grouped_kv_mqa__prompt_kernel_qdone
gated_mix__ssm_conv_h3__grouped_kv_mqa__prompt_kernel_g2:
  s_waitcnt vmcnt(9)
  v_mov_b32 v10, 162016
  v_mov_b32 v11, 1
  s_mov_b64 exec, 1
  ds_add_u32 v10, v11
  s_mov_b64 exec, -1
  v_mov_b32 v10, 162016
  s_mov_b32 s63, 0
gated_mix__ssm_conv_h3__grouped_kv_mqa__prompt_kernel_wb0:
  ds_read_b32 v11, v10
  s_waitcnt lgkmcnt(0)
  v_readfirstlane_b32 s69, v11
  s_nop 3
  s_cmp_ge_u32 s69, 8
  s_cbranch_scc1 gated_mix__ssm_conv_h3__grouped_kv_mqa__prompt_kernel_wb0_ok
  s_add_u32 s63, s63, 1
  s_cmp_gt_u32 s63, 1000000
  s_cbranch_scc1 gated_mix__ssm_conv_h3__grouped_kv_mqa__prompt_kernel_exit
  s_branch gated_mix__ssm_conv_h3__grouped_kv_mqa__prompt_kernel_wb0
gated_mix__ssm_conv_h3__grouped_kv_mqa__prompt_kernel_wb0_ok:
  ds_read_b64_tr_b16 v[16:17], v9 offset:20576
  ds_read_b64_tr_b16 v[18:19], v9 offset:21344
  ds_read_b64_tr_b16 v[20:21], v9 offset:20608
  ds_read_b64_tr_b16 v[22:23], v9 offset:21376
  ds_read_b64_tr_b16 v[24:25], v9 offset:26720
  ds_read_b64_tr_b16 v[26:27], v9 offset:27488
  ds_read_b64_tr_b16 v[28:29], v9 offset:26752
  ds_read_b64_tr_b16 v[30:31], v9 offset:27520
  s_waitcnt lgkmcnt(4)
  v_mfma_f32_16x16x32_bf16 v[144:147], v[16:19], v[64:67], v[144:147]
  ds_read_b64_tr_b16 v[32:33], v9 offset:32864
  ds_read_b64_tr_b16 v[34:35], v9 offset:33632
  v_mfma_f32_16x16x32_bf16 v[148:151], v[20:23], v[64:67], v[148:151]
  ds_read_b64_tr_b16 v[36:37], v9 offset:32896
  ds_read_b64_tr_b16 v[38:39], v9 offset:33664
  s_waitcnt lgkmcnt(4)
  v_mfma_f32_16x16x32_bf16 v[144:147], v[24:27], v[68:71], v[144:147]
  ds_read_b64_tr_b16 v[16:17], v9 offset:39008
  ds_read_b64_tr_b16 v[18:19], v9 offset:39776
  v_mfma_f32_16x16x32_bf16 v[148:151], v[28:31], v[68:71], v[148:151]
  ds_read_b64_tr_b16 v[20:21], v9 offset:39040
  ds_read_b64_tr_b16 v[22:23], v9 offset:39808
  s_waitcnt lgkmcnt(4)
  v_mfma_f32_16x16x32_bf16 v[144:147], v[32:35], v[72:75], v[144:147]
  ds_read_b64_tr_b16 v[24:25], v9 offset:45152
  ds_read_b64_tr_b16 v[26:27], v9 offset:45920
  v_mfma_f32_16x16x32_bf16 v[148:151], v[36:39], v[72:75], v[148:151]
  ds_read_b64_tr_b16 v[28:29], v9 offset:45184
  ds_read_b64_tr_b16 v[30:31], v9 offset:45952
  s_waitcnt lgkmcnt(4)
  v_mfma_f32_16x16x32_bf16 v[144:147], v[16:19], v[76:79], v[144:147]
  ds_read_b64_tr_b16 v[32:33], v9 offset:51296
  ds_read_b64_tr_b16 v[34:35], v9 offset:52064
  v_mfma_f32_16x16x32_bf16 v[148:151], v[20:23], v[76:79], v[148:151]
  ds_read_b64_tr_b16 v[36:37], v9 offset:51328
  ds_read_b64_tr_b16 v[38:39], v9 offset:52096
  s_waitcnt lgkmcnt(4)
  v_mfma_f32_16x16x32_bf16 v[144:147], v[24:27], v[80:83], v[144:147]
  ds_read_b64_tr_b16 v[16:17], v9 offset:57440
  ds_read_b64_tr_b16 v[18:19], v9 offset:58208
  v_mfma_f32_16x16x32_bf16 v[148:151], v[28:31], v[80:83], v[148:151]
  ds_read_b64_tr_b16 v[20:21], v9 offset:57472
  ds_read_b64_tr_b16 v[22:23], v9 offset:58240
  s_waitcnt lgkmcnt(4)
  v_mfma_f32_16x16x32_bf16 v[144:147], v[32:35], v[84:87], v[144:147]
  ds_read_b64_tr_b16 v[24:25], v9 offset:63584
  ds_read_b64_tr_b16 v[26:27], v9 offset:64352
  v_mfma_f32_16x16x32_bf16 v[148:151], v[36:39], v[84:87], v[148:151]
  ds_read_b64_tr_b16 v[28:29], v9 offset:63616
  ds_read_b64_tr_b16 v[30:31], v9 offset:64384
  s_waitcnt lgkmcnt(4)
  v_mfma_f32_16x16x32_bf16 v[144:147], v[16:19], v[88:91], v[144:147]
  v_mfma_f32_16x16x32_bf16 v[148:151], v[20:23], v[88:91], v[148:151]
  s_waitcnt lgkmcnt(0)
  v_mfma_f32_16x16x32_bf16 v[144:147], v[24:27], v[92:95], v[144:147]
  v_mfma_f32_16x16x32_bf16 v[148:151], v[28:31], v[92:95], v[148:151]
  v_mov_b32 v10, 162052
  v_mov_b32 v11, 1
  s_mov_b64 exec, 1
  ds_add_u32 v10, v11
  s_mov_b64 exec, -1
  s_lshl_b32 s64, s59, 2
  s_add_u32 s64, s64, 162000
  s_and_b32 s62, s57, 3
  s_cmp_eq_u32 s62, s59
  s_cselect_b32 s66, 4, 2
  v_mov_b32 v10, s64
  s_mov_b32 s63, 0
gated_mix__ssm_conv_h3__grouped_kv_mqa__prompt_kernel_xrb:
  ds_read_b32 v11, v10
  s_waitcnt lgkmcnt(0)
  v_readfirstlane_b32 s69, v11
  s_nop 3
  s_cmp_ge_u32 s69, s66
  s_cbranch_scc1 gated_mix__ssm_conv_h3__grouped_kv_mqa__prompt_kernel_xrb_ok
  s_add_u32 s63, s63, 1
  s_cmp_gt_u32 s63, 1000000
  s_cbranch_scc1 gated_mix__ssm_conv_h3__grouped_kv_mqa__prompt_kernel_exit
  s_branch gated_mix__ssm_conv_h3__grouped_kv_mqa__prompt_kernel_xrb
gated_mix__ssm_conv_h3__grouped_kv_mqa__prompt_kernel_xrb_ok:
  s_mul_i32 s60, s59, 20480
  s_mul_i32 s61, s65, 3072
  s_add_u32 s60, s60, s61
  v_lshlrev_b32 v13, 4, v1
  v_add_u32 v13, s60, v13
  s_waitcnt vmcnt(0)
  ds_write_b128 v13, v[40:43] offset:0
  ds_write_b128 v13, v[44:47] offset:1024
  ds_write_b128 v13, v[48:51] offset:2048
  ds_write_b128 v13, v[52:55] offset:6144
  ds_write_b128 v13, v[56:59] offset:7168
  ds_write_b128 v13, v[60:63] offset:8192
  ds_write_b128 v13, v[156:159] offset:12288
  ds_write_b128 v13, v[160:163] offset:13312
  ds_write_b128 v13, v[164:167] offset:14336
  s_waitcnt lgkmcnt(0)
  v_mov_b32 v10, 162020
  v_mov_b32 v11, 1
  s_mov_b64 exec, 1
  ds_add_u32 v10, v11
  s_mov_b64 exec, -1
  v_mov_b32 v10, 162020
  s_mov_b32 s63, 0
gated_mix__ssm_conv_h3__grouped_kv_mqa__prompt_kernel_wb1:
  ds_read_b32 v11, v10
  s_waitcnt lgkmcnt(0)
  v_readfirstlane_b32 s69, v11
  s_nop 3
  s_cmp_ge_u32 s69, 8
  s_cbranch_scc1 gated_mix__ssm_conv_h3__grouped_kv_mqa__prompt_kernel_wb1_ok
  s_add_u32 s63, s63, 1
  s_cmp_gt_u32 s63, 1000000
  s_cbranch_scc1 gated_mix__ssm_conv_h3__grouped_kv_mqa__prompt_kernel_exit
  s_branch gated_mix__ssm_conv_h3__grouped_kv_mqa__prompt_kernel_wb1
gated_mix__ssm_conv_h3__grouped_kv_mqa__prompt_kernel_wb1_ok:
  ds_read_b64_tr_b16 v[16:17], v8 offset:96
  ds_read_b64_tr_b16 v[18:19], v8 offset:864
  ds_read_b64_tr_b16 v[20:21], v8 offset:128
  ds_read_b64_tr_b16 v[22:23], v8 offset:896
  ds_read_b64_tr_b16 v[24:25], v8 offset:6240
  ds_read_b64_tr_b16 v[26:27], v8 offset:7008
  ds_read_b64_tr_b16 v[28:29], v8 offset:6272
  ds_read_b64_tr_b16 v[30:31], v8 offset:7040
  ds_read_b64_tr_b16 v[32:33], v8 offset:12384
  ds_read_b64_tr_b16 v[34:35], v8 offset:13152
  ds_read_b64_tr_b16 v[36:37], v8 offset:12416
  ds_read_b64_tr_b16 v[38:39], v8 offset:13184
  s_waitcnt lgkmcnt(8)
  v_mfma_f32_16x16x32_bf16 v[144:147], v[16:19], v[96:99], v[144:147]
  ds_read_b64_tr_b16 v[40:41], v8 offset:20576
  ds_read_b64_tr_b16 v[42:43], v8 offset:21344
  v_mfma_f32_16x16x32_bf16 v[148:151], v[20:23], v[96:99], v[148:151]
  ds_read_b64_tr_b16 v[44:45], v8 offset:20608
  ds_read_b64_tr_b16 v[46:47], v8 offset:21376
  s_waitcnt lgkmcnt(8)
  v_mfma_f32_16x16x32_bf16 v[144:147], v[24:27], v[100:103], v[144:147]
  ds_read_b64_tr_b16 v[16:17], v8 offset:26720
  ds_read_b64_tr_b16 v[18:19], v8 offset:27488
  v_mfma_f32_16x16x32_bf16 v[148:151], v[28:31], v[100:103], v[148:151]
  ds_read_b64_tr_b16 v[20:21], v8 offset:26752
  ds_read_b64_tr_b16 v[22:23], v8 offset:27520
  s_waitcnt lgkmcnt(8)
  v_mfma_f32_16x16x32_bf16 v[144:147], v[32:35], v[104:107], v[144:147]
  ds_read_b64_tr_b16 v[24:25], v8 offset:32864
  ds_read_b64_tr_b16 v[26:27], v8 offset:33632
  v_mfma_f32_16x16x32_bf16 v[148:151], v[36:39], v[104:107], v[148:151]
  ds_read_b64_tr_b16 v[28:29], v8 offset:32896
  ds_read_b64_tr_b16 v[30:31], v8 offset:33664
  s_waitcnt lgkmcnt(8)
  v_mfma_f32_16x16x32_bf16 v[144:147], v[40:43], v[108:111], v[144:147]
  ds_read_b64_tr_b16 v[32:33], v8 offset:41056
  ds_read_b64_tr_b16 v[34:35], v8 offset:41824
  v_mfma_f32_16x16x32_bf16 v[148:151], v[44:47], v[108:111], v[148:151]
  ds_read_b64_tr_b16 v[36:37], v8 offset:41088
  ds_read_b64_tr_b16 v[38:39], v8 offset:41856
  s_waitcnt lgkmcnt(8)
  v_mfma_f32_16x16x32_bf16 v[144:147], v[16:19], v[112:115], v[144:147]
  ds_read_b64_tr_b16 v[40:41], v8 offset:47200
  ds_read_b64_tr_b16 v[42:43], v8 offset:47968
  v_mfma_f32_16x16x32_bf16 v[148:151], v[20:23], v[112:115], v[148:151]
  ds_read_b64_tr_b16 v[44:45], v8 offset:47232
  ds_read_b64_tr_b16 v[46:47], v8 offset:48000
  s_waitcnt lgkmcnt(8)
  v_mfma_f32_16x16x32_bf16 v[144:147], v[24:27], v[116:119], v[144:147]
  ds_read_b64_tr_b16 v[16:17], v8 offset:53344
  ds_read_b64_tr_b16 v[18:19], v8 offset:54112
  v_mfma_f32_16x16x32_bf16 v[148:151], v[28:31], v[116:119], v[148:151]
  ds_read_b64_tr_b16 v[20:21], v8 offset:53376
  ds_read_b64_tr_b16 v[22:23], v8 offset:54144
  s_waitcnt lgkmcnt(8)
  v_mfma_f32_16x16x32_bf16 v[144:147], v[32:35], v[120:123], v[144:147]
  ds_read_b64_tr_b16 v[24:25], v8 offset:61536
  ds_read_b64_tr_b16 v[26:27], v8 offset:62304
  v_mfma_f32_16x16x32_bf16 v[148:151], v[36:39], v[120:123], v[148:151]
  ds_read_b64_tr_b16 v[28:29], v8 offset:61568
  ds_read_b64_tr_b16 v[30:31], v8 offset:62336
  s_waitcnt lgkmcnt(8)
  v_mfma_f32_16x16x32_bf16 v[144:147], v[40:43], v[124:127], v[144:147]
  ds_read_b64_tr_b16 v[32:33], v9 offset:6240
  ds_read_b64_tr_b16 v[34:35], v9 offset:7008
  v_mfma_f32_16x16x32_bf16 v[148:151], v[44:47], v[124:127], v[148:151]
  ds_read_b64_tr_b16 v[36:37], v9 offset:6272
  ds_read_b64_tr_b16 v[38:39], v9 offset:7040
  s_waitcnt lgkmcnt(8)
  v_mfma_f32_16x16x32_bf16 v[144:147], v[16:19], v[128:131], v[144:147]
  ds_read_b64_tr_b16 v[40:41], v9 offset:12384
  ds_read_b64_tr_b16 v[42:43], v9 offset:13152
  v_mfma_f32_16x16x32_bf16 v[148:151], v[20:23], v[128:131], v[148:151]
  ds_read_b64_tr_b16 v[44:45], v9 offset:12416
  ds_read_b64_tr_b16 v[46:47], v9 offset:13184
  s_waitcnt lgkmcnt(8)
  v_mfma_f32_16x16x32_bf16 v[144:147], v[24:27], v[132:135], v[144:147]
  v_mfma_f32_16x16x32_bf16 v[148:151], v[28:31], v[132:135], v[148:151]
  s_waitcnt lgkmcnt(4)
  v_mfma_f32_16x16x32_bf16 v[144:147], v[32:35], v[136:139], v[144:147]
  v_mfma_f32_16x16x32_bf16 v[148:151], v[36:39], v[136:139], v[148:151]
  s_waitcnt lgkmcnt(0)
  v_mfma_f32_16x16x32_bf16 v[144:147], v[40:43], v[140:143], v[144:147]
  v_mfma_f32_16x16x32_bf16 v[148:151], v[44:47], v[140:143], v[148:151]
  s_lshl_b32 s60, s59, 4
  v_add_u32 v13, s60, v2
  v_mul_u32_u24 v13, 160, v13
  v_lshl_add_u32 v13, v3, 3, v13
  v_add_u32 v13, 101376, v13
  s_mov_b32 s61, 0x3ea52b5c
  s_nop 0
  v_mul_f32 v144, s61, v144
  v_mul_f32 v145, s61, v145
  v_mul_f32 v146, s61, v146
  v_mul_f32 v147, s61, v147
  v_cvt_pk_bf16_f32 v144, v144, v145
  v_cvt_pk_bf16_f32 v145, v146, v147
  ds_write_b64 v13, v[144:145] offset:96
  v_mul_f32 v148, s61, v148
  v_mul_f32 v149, s61, v149
  v_mul_f32 v150, s61, v150
  v_mul_f32 v151, s61, v151
  v_cvt_pk_bf16_f32 v148, v148, v149
  v_cvt_pk_bf16_f32 v149, v150, v151
  ds_write_b64 v13, v[148:149] offset:128
  s_branch gated_mix__ssm_conv_h3__grouped_kv_mqa__prompt_kernel_qdone
gated_mix__ssm_conv_h3__grouped_kv_mqa__prompt_kernel_qdone:
  s_waitcnt lgkmcnt(0)
  v_mov_b32 v10, 162056
  v_mov_b32 v11, 1
  s_mov_b64 exec, 1
  ds_add_u32 v10, v11
  s_mov_b64 exec, -1
  v_and_b32 v2, 31, v1
  v_lshrrev_b32 v3, 5, v1
  s_lshr_b32 s66, s58, 2
  s_mul_i32 s66, s66, 2640
  s_add_u32 s66, s66, 79872
  v_lshlrev_b32 v142, 4, v1
  v_add_u32 v142, s66, v142
  v_lshlrev_b32 v150, 3, v2
  v_add_u32 v150, 1024, v150
  v_mov_b32 v151, 1280
  v_cmp_eq_u32 vcc, 0, v3
  v_min_u32 v152, 20, v2
  v_subrev_u32 v153, 12, v2
  v_cndmask_b32 v143, v151, v150, vcc
  v_add_u32 v143, s66, v143
  v_cmp_lt_u32 vcc, 27, v2
  v_mul_u32_u24 v151, 336, v3
  s_nop 0
  v_cndmask_b32 v152, v152, v153, vcc
  v_lshl_add_u32 v144, v152, 4, v151
  v_add_u32 v144, s66, v144
  v_add_u32 v144, 1296, v144
  s_mov_b32 s67, 0xa800
  v_add_u32 v145, s67, v142
  v_add_u32 v146, s67, v143
  v_add_u32 v147, s67, v144
  v_mov_b32 v80, 0
  v_mov_b32 v81, 0
  v_mov_b32 v82, 0
  v_mov_b32 v83, 0
  v_mov_b32 v84, 0
  v_mov_b32 v85, 0
  v_mov_b32 v86, 0
  v_mov_b32 v87, 0
  v_mov_b32 v88, 0
  v_mov_b32 v89, 0
  v_mov_b32 v90, 0
  v_mov_b32 v91, 0
  v_mov_b32 v92, 0
  v_mov_b32 v93, 0
  v_mov_b32 v94, 0
  v_mov_b32 v95, 0
  v_mov_b32 v96, 0
  v_mov_b32 v97, 0
  v_mov_b32 v98, 0
  v_mov_b32 v99, 0
  v_mov_b32 v100, 0
  v_mov_b32 v101, 0
  v_mov_b32 v102, 0
  v_mov_b32 v103, 0
  v_mov_b32 v104, 0
  v_mov_b32 v105, 0
  v_mov_b32 v106, 0
  v_mov_b32 v107, 0
  v_mov_b32 v108, 0
  v_mov_b32 v109, 0
  v_mov_b32 v110, 0
  v_mov_b32 v111, 0
  v_mov_b32 v10, 162056
  s_mov_b32 s63, 0
gated_mix__ssm_conv_h3__grouped_kv_mqa__prompt_kernel_qsp:
  ds_read_b32 v11, v10
  s_waitcnt lgkmcnt(0)
  v_readfirstlane_b32 s69, v11
  s_nop 3
  s_cmp_ge_u32 s69, 8
  s_cbranch_scc1 gated_mix__ssm_conv_h3__grouped_kv_mqa__prompt_kernel_qsp_ok
  s_add_u32 s63, s63, 1
  s_cmp_gt_u32 s63, 1000000
  s_cbranch_scc1 gated_mix__ssm_conv_h3__grouped_kv_mqa__prompt_kernel_exit
  s_branch gated_mix__ssm_conv_h3__grouped_kv_mqa__prompt_kernel_qsp
gated_mix__ssm_conv_h3__grouped_kv_mqa__prompt_kernel_qsp_ok:
  v_and_b32 v2, 31, v1
  v_lshrrev_b32 v3, 5, v1
  s_and_b32 s60, s58, 3
  s_mul_i32 s60, s60, 40
  s_add_u32 s60, s60, 101376
  v_mul_u32_u24 v150, 160, v2
  v_add_u32 v150, s60, v150
  v_lshl_add_u32 v151, v3, 4, v150
  ds_read_b64 v[4:5], v151
  ds_read_b64 v[6:7], v151 offset:8
  ds_read_b64 v[8:9], v150 offset:32
  ds_read_b64 v[10:11], v151 offset:5120
  ds_read_b64 v[12:13], v151 offset:5128
  ds_read_b64 v[14:15], v150 offset:5152
  s_waitcnt lgkmcnt(0)
  v_cmp_eq_u32 vcc, 0, v3
  s_nop 1
  v_cndmask_b32 v160, v14, v8, vcc
  v_cndmask_b32 v161, v15, v9, vcc
  v_cndmask_b32 v8, 0, v8, vcc
  v_cndmask_b32 v9, 0, v9, vcc
  v_cndmask_b32 v14, 0, v14, vcc
  v_cndmask_b32 v15, 0, v15, vcc
  v_mov_b32 v154, 0
  v_dot2_f32_bf16 v154, v4, v4, v154
  v_dot2_f32_bf16 v154, v5, v5, v154
  v_dot2_f32_bf16 v154, v6, v6, v154
  v_dot2_f32_bf16 v154, v7, v7, v154
  v_dot2_f32_bf16 v154, v8, v8, v154
  v_dot2_f32_bf16 v154, v9, v9, v154
  s_nop 2
  v_mov_b32 v156, v154
  s_nop 1
  v_permlane32_swap_b32 v154, v156
  v_add_f32 v154, v154, v156
  v_mov_b32 v155, 0
  v_dot2_f32_bf16 v155, v10, v10, v155
  v_dot2_f32_bf16 v155, v11, v11, v155
  v_dot2_f32_bf16 v155, v12, v12, v155
  v_dot2_f32_bf16 v155, v13, v13, v155
  v_dot2_f32_bf16 v155, v14, v14, v155
  v_dot2_f32_bf16 v155, v15, v15, v155
  s_nop 2
  v_mov_b32 v156, v155
  s_nop 1
  v_permlane32_swap_b32 v155, v156
  v_add_f32 v155, v155, v156
  v_max_f32 v156, v154, v155
  s_nop 1
  v_max_f32_dpp v156, v156, v156 row_shr:1 row_mask:0xf bank_mask:0xf
  s_nop 1
  v_max_f32_dpp v156, v156, v156 row_shr:2 row_mask:0xf bank_mask:0xf
  s_nop 1
  v_max_f32_dpp v156, v156, v156 row_shr:4 row_mask:0xf bank_mask:0xf
  s_nop 1
  v_max_f32_dpp v156, v156, v156 row_shr:8 row_mask:0xf bank_mask:0xf
  s_nop 1
  v_max_f32_dpp v156, v156, v156 row_bcast:15 row_mask:0xa bank_mask:0xf
  v_mov_b32 v157, 161856
  v_cmp_eq_u32 vcc, 31, v1
  s_nop 3
  s_and_saveexec_b64 s[62:63], vcc
  ds_max_u32 v157, v156
  s_mov_b64 exec, s[62:63]
  s_waitcnt lgkmcnt(0)
  v_mov_b32 v156, 162068
  v_mov_b32 v157, 1
  s_mov_b64 exec, 1
  ds_add_u32 v156, v157
  s_mov_b64 exec, -1
  v_mov_b32 v156, 161880
  s_mov_b32 s63, 0
gated_mix__ssm_conv_h3__grouped_kv_mqa__prompt_kernel_l0sp:
  ds_read_b32 v157, v156
  s_waitcnt lgkmcnt(0)
  v_readfirstlane_b32 s69, v157
  s_nop 3
  s_cmp_ge_u32 s69, 1
  s_cbranch_scc1 gated_mix__ssm_conv_h3__grouped_kv_mqa__prompt_kernel_l0sp_ok
  s_add_u32 s63, s63, 1
  s_cmp_gt_u32 s63, 1000000
  s_cbranch_scc1 gated_mix__ssm_conv_h3__grouped_kv_mqa__prompt_kernel_exit
  s_branch gated_mix__ssm_conv_h3__grouped_kv_mqa__prompt_kernel_l0sp
gated_mix__ssm_conv_h3__grouped_kv_mqa__prompt_kernel_l0sp_ok:
  ds_read_b128 v[128:131], v142
  ds_read_b64 v[132:133], v143
  s_mov_b32 s67, 0
  s_waitcnt lgkmcnt(0)
  v_mfma_f32_32x32x16_bf16 v[16:31], v[128:131], v[4:7], 0
  v_mfma_f32_32x32x16_bf16 v[32:47], v[128:131], v[10:13], 0
  v_mfma_f32_32x32x8_bf16 v[16:31], v[132:133], v[8:9], v[16:31]
  v_mfma_f32_32x32x8_bf16 v[32:47], v[132:133], v[14:15], v[32:47]
  ds_read_b128 v[128:131], v142 offset:5280
  ds_read_b64 v[132:133], v143 offset:5280
  ds_read_b128 v[134:137], v144
  ds_read_b128 v[138:141], v144 offset:672
  s_mov_b32 s70, 0
  s_mov_b32 s68, 1
  s_add_u32 s71, s67, 2
  s_add_u32 s67, s67, 8
  v_mov_b32 v148, 161880
  v_mov_b32 v149, 1
  s_nop 15
.p2align 6
gated_mix__ssm_conv_h3__grouped_kv_mqa__prompt_kernel_loop:
  s_setprio 2
  s_waitcnt lgkmcnt(2)
  v_mfma_f32_32x32x16_bf16 v[48:63], v[128:131], v[4:7], 0
  v_exp_f32 v16, v16
  v_exp_f32 v17, v17
  v_exp_f32 v18, v18
  v_exp_f32 v19, v19
  v_mfma_f32_32x32x16_bf16 v[64:79], v[128:131], v[10:13], 0
  v_exp_f32 v20, v20
  v_exp_f32 v21, v21
  v_exp_f32 v22, v22
  v_exp_f32 v23, v23
  v_mfma_f32_32x32x8_bf16 v[48:63], v[132:133], v[8:9], v[48:63]
  v_cvt_pk_bf16_f32 v112, v16, v17
  v_cvt_pk_bf16_f32 v113, v18, v19
  v_cvt_pk_bf16_f32 v114, v20, v21
  v_cvt_pk_bf16_f32 v115, v22, v23
  v_exp_f32 v24, v24
  v_exp_f32 v25, v25
  v_mfma_f32_32x32x8_bf16 v[64:79], v[132:133], v[14:15], v[64:79]
  ds_read_b128 v[128:131], v142 offset:10560
  ds_read_b64 v[132:133], v143 offset:10560
  v_exp_f32 v26, v26
  v_exp_f32 v27, v27
  v_exp_f32 v28, v28
  v_exp_f32 v29, v29
  s_waitcnt lgkmcnt(3)
  v_mfma_f32_32x32x16_bf16 v[80:95], v[134:137], v[112:115], v[80:95]
  v_exp_f32 v30, v30
  v_exp_f32 v31, v31
  v_exp_f32 v32, v32
  v_exp_f32 v33, v33
  v_cvt_pk_bf16_f32 v116, v24, v25
  v_cvt_pk_bf16_f32 v117, v26, v27
  v_cvt_pk_bf16_f32 v118, v28, v29
  v_cvt_pk_bf16_f32 v119, v30, v31
  v_exp_f32 v34, v34
  v_exp_f32 v35, v35
  s_waitcnt lgkmcnt(2)
  v_mfma_f32_32x32x16_bf16 v[80:95], v[138:141], v[116:119], v[80:95]
  v_exp_f32 v36, v36
  v_exp_f32 v37, v37
  v_exp_f32 v38, v38
  v_exp_f32 v39, v39
  v_cvt_pk_bf16_f32 v120, v32, v33
  v_cvt_pk_bf16_f32 v121, v34, v35
  v_cvt_pk_bf16_f32 v122, v36, v37
  v_cvt_pk_bf16_f32 v123, v38, v39
  v_exp_f32 v40, v40
  v_exp_f32 v41, v41
  v_mfma_f32_32x32x16_bf16 v[96:111], v[134:137], v[120:123], v[96:111]
  ds_read_b128 v[134:137], v144 offset:5280
  v_exp_f32 v42, v42
  v_exp_f32 v43, v43
  v_exp_f32 v44, v44
  v_exp_f32 v45, v45
  v_exp_f32 v46, v46
  v_exp_f32 v47, v47
  v_cvt_pk_bf16_f32 v124, v40, v41
  v_cvt_pk_bf16_f32 v125, v42, v43
  v_cvt_pk_bf16_f32 v126, v44, v45
  v_cvt_pk_bf16_f32 v127, v46, v47
  s_nop 1
  v_mfma_f32_32x32x16_bf16 v[96:111], v[138:141], v[124:127], v[96:111]
  ds_read_b128 v[138:141], v144 offset:5952
  s_setprio 1
  s_waitcnt lgkmcnt(2)
  v_mfma_f32_32x32x16_bf16 v[16:31], v[128:131], v[4:7], 0
  v_exp_f32 v48, v48
  v_exp_f32 v49, v49
  v_exp_f32 v50, v50
  v_exp_f32 v51, v51
  v_mfma_f32_32x32x16_bf16 v[32:47], v[128:131], v[10:13], 0
  v_exp_f32 v52, v52
  v_exp_f32 v53, v53
  v_exp_f32 v54, v54
  v_exp_f32 v55, v55
  v_mfma_f32_32x32x8_bf16 v[16:31], v[132:133], v[8:9], v[16:31]
  v_cvt_pk_bf16_f32 v112, v48, v49
  v_cvt_pk_bf16_f32 v113, v50, v51
  v_cvt_pk_bf16_f32 v114, v52, v53
  v_cvt_pk_bf16_f32 v115, v54, v55
  v_exp_f32 v56, v56
  v_exp_f32 v57, v57
  v_mfma_f32_32x32x8_bf16 v[32:47], v[132:133], v[14:15], v[32:47]
  ds_read_b128 v[128:131], v142 offset:15840
  ds_read_b64 v[132:133], v143 offset:15840
  ds_read_b32 v167, v148
  v_exp_f32 v58, v58
  v_exp_f32 v59, v59
  v_exp_f32 v60, v60
  v_exp_f32 v61, v61
  s_waitcnt lgkmcnt(4)
  v_mfma_f32_32x32x16_bf16 v[80:95], v[134:137], v[112:115], v[80:95]
  v_exp_f32 v62, v62
  v_exp_f32 v63, v63
  v_exp_f32 v64, v64
  v_exp_f32 v65, v65
  v_cvt_pk_bf16_f32 v116, v56, v57
  v_cvt_pk_bf16_f32 v117, v58, v59
  v_cvt_pk_bf16_f32 v118, v60, v61
  v_cvt_pk_bf16_f32 v119, v62, v63
  v_exp_f32 v66, v66
  v_exp_f32 v67, v67
  s_waitcnt lgkmcnt(3)
  v_mfma_f32_32x32x16_bf16 v[80:95], v[138:141], v[116:119], v[80:95]
  v_exp_f32 v68, v68
  v_exp_f32 v69, v69
  v_exp_f32 v70, v70
  v_exp_f32 v71, v71
  v_cvt_pk_bf16_f32 v120, v64, v65
  v_cvt_pk_bf16_f32 v121, v66, v67
  v_cvt_pk_bf16_f32 v122, v68, v69
  v_cvt_pk_bf16_f32 v123, v70, v71
  v_exp_f32 v72, v72
  v_exp_f32 v73, v73
  v_mfma_f32_32x32x16_bf16 v[96:111], v[134:137], v[120:123], v[96:111]
  ds_read_b128 v[134:137], v144 offset:10560
  v_exp_f32 v74, v74
  v_exp_f32 v75, v75
  v_exp_f32 v76, v76
  v_exp_f32 v77, v77
  v_exp_f32 v78, v78
  v_exp_f32 v79, v79
  v_cvt_pk_bf16_f32 v124, v72, v73
  v_cvt_pk_bf16_f32 v125, v74, v75
  v_cvt_pk_bf16_f32 v126, v76, v77
  v_cvt_pk_bf16_f32 v127, v78, v79
  s_nop 1
  v_mfma_f32_32x32x16_bf16 v[96:111], v[138:141], v[124:127], v[96:111]
  ds_read_b128 v[138:141], v144 offset:11232
  s_setprio 3
  s_waitcnt lgkmcnt(2)
  v_readfirstlane_b32 s69, v167
  s_nop 3
  s_cmp_ge_u32 s69, s71
  s_cbranch_scc0 gated_mix__ssm_conv_h3__grouped_kv_mqa__prompt_kernel_lspin
gated_mix__ssm_conv_h3__grouped_kv_mqa__prompt_kernel_lback:
  v_mfma_f32_32x32x16_bf16 v[48:63], v[128:131], v[4:7], 0
  v_exp_f32 v16, v16
  v_exp_f32 v17, v17
  v_exp_f32 v18, v18
  v_exp_f32 v19, v19
  v_mfma_f32_32x32x16_bf16 v[64:79], v[128:131], v[10:13], 0
  v_exp_f32 v20, v20
  v_exp_f32 v21, v21
  v_exp_f32 v22, v22
  v_exp_f32 v23, v23
  v_mfma_f32_32x32x8_bf16 v[48:63], v[132:133], v[8:9], v[48:63]
  v_cvt_pk_bf16_f32 v112, v16, v17
  v_cvt_pk_bf16_f32 v113, v18, v19
  v_cvt_pk_bf16_f32 v114, v20, v21
  v_cvt_pk_bf16_f32 v115, v22, v23
  v_exp_f32 v24, v24
  v_exp_f32 v25, v25
  v_mfma_f32_32x32x8_bf16 v[64:79], v[132:133], v[14:15], v[64:79]
  ds_read_b128 v[128:131], v145 offset:0
  ds_read_b64 v[132:133], v146 offset:0
  s_mov_b64 exec, 1
  ds_add_u32 v148, v149 offset:4
  s_mov_b64 exec, -1
  v_exp_f32 v26, v26
  v_exp_f32 v27, v27
  v_exp_f32 v28, v28
  v_exp_f32 v29, v29
  s_waitcnt lgkmcnt(4)
  v_mfma_f32_32x32x16_bf16 v[80:95], v[134:137], v[112:115], v[80:95]
  v_exp_f32 v30, v30
  v_exp_f32 v31, v31
  v_exp_f32 v32, v32
  v_exp_f32 v33, v33
  v_cvt_pk_bf16_f32 v116, v24, v25
  v_cvt_pk_bf16_f32 v117, v26, v27
  v_cvt_pk_bf16_f32 v118, v28, v29
  v_cvt_pk_bf16_f32 v119, v30, v31
  v_exp_f32 v34, v34
  v_exp_f32 v35, v35
  s_waitcnt lgkmcnt(3)
  v_mfma_f32_32x32x16_bf16 v[80:95], v[138:141], v[116:119], v[80:95]
  v_exp_f32 v36, v36
  v_exp_f32 v37, v37
  v_exp_f32 v38, v38
  v_exp_f32 v39, v39
  v_cvt_pk_bf16_f32 v120, v32, v33
  v_cvt_pk_bf16_f32 v121, v34, v35
  v_cvt_pk_bf16_f32 v122, v36, v37
  v_cvt_pk_bf16_f32 v123, v38, v39
  v_exp_f32 v40, v40
  v_exp_f32 v41, v41
  v_mfma_f32_32x32x16_bf16 v[96:111], v[134:137], v[120:123], v[96:111]
  ds_read_b128 v[134:137], v144 offset:15840
  v_exp_f32 v42, v42
  v_exp_f32 v43, v43
  v_exp_f32 v44, v44
  v_exp_f32 v45, v45
  v_exp_f32 v46, v46
  v_exp_f32 v47, v47
  v_cvt_pk_bf16_f32 v124, v40, v41
  v_cvt_pk_bf16_f32 v125, v42, v43
  v_cvt_pk_bf16_f32 v126, v44, v45
  v_cvt_pk_bf16_f32 v127, v46, v47
  s_nop 1
  v_mfma_f32_32x32x16_bf16 v[96:111], v[138:141], v[124:127], v[96:111]
  ds_read_b128 v[138:141], v144 offset:16512
  s_setprio 2
  s_waitcnt lgkmcnt(2)
  v_mfma_f32_32x32x16_bf16 v[16:31], v[128:131], v[4:7], 0
  v_exp_f32 v48, v48
  v_exp_f32 v49, v49
  v_exp_f32 v50, v50
  v_exp_f32 v51, v51
  v_mfma_f32_32x32x16_bf16 v[32:47], v[128:131], v[10:13], 0
  v_exp_f32 v52, v52
  v_exp_f32 v53, v53
  v_exp_f32 v54, v54
  v_exp_f32 v55, v55
  v_mfma_f32_32x32x8_bf16 v[16:31], v[132:133], v[8:9], v[16:31]
  v_cvt_pk_bf16_f32 v112, v48, v49
  v_cvt_pk_bf16_f32 v113, v50, v51
  v_cvt_pk_bf16_f32 v114, v52, v53
  v_cvt_pk_bf16_f32 v115, v54, v55
  v_exp_f32 v56, v56
  v_exp_f32 v57, v57
  v_mfma_f32_32x32x8_bf16 v[32:47], v[132:133], v[14:15], v[32:47]
  ds_read_b128 v[128:131], v145 offset:5280
  ds_read_b64 v[132:133], v146 offset:5280
  v_exp_f32 v58, v58
  v_exp_f32 v59, v59
  v_exp_f32 v60, v60
  v_exp_f32 v61, v61
  s_waitcnt lgkmcnt(3)
  v_mfma_f32_32x32x16_bf16 v[80:95], v[134:137], v[112:115], v[80:95]
  v_exp_f32 v62, v62
  v_exp_f32 v63, v63
  v_exp_f32 v64, v64
  v_exp_f32 v65, v65
  v_cvt_pk_bf16_f32 v116, v56, v57
  v_cvt_pk_bf16_f32 v117, v58, v59
  v_cvt_pk_bf16_f32 v118, v60, v61
  v_cvt_pk_bf16_f32 v119, v62, v63
  v_exp_f32 v66, v66
  v_exp_f32 v67, v67
  s_waitcnt lgkmcnt(2)
  v_mfma_f32_32x32x16_bf16 v[80:95], v[138:141], v[116:119], v[80:95]
  v_exp_f32 v68, v68
  v_exp_f32 v69, v69
  v_exp_f32 v70, v70
  v_exp_f32 v71, v71
  v_cvt_pk_bf16_f32 v120, v64, v65
  v_cvt_pk_bf16_f32 v121, v66, v67
  v_cvt_pk_bf16_f32 v122, v68, v69
  v_cvt_pk_bf16_f32 v123, v70, v71
  v_exp_f32 v72, v72
  v_exp_f32 v73, v73
  v_mfma_f32_32x32x16_bf16 v[96:111], v[134:137], v[120:123], v[96:111]
  ds_read_b128 v[134:137], v147 offset:0
  v_exp_f32 v74, v74
  v_exp_f32 v75, v75
  v_exp_f32 v76, v76
  v_exp_f32 v77, v77
  v_exp_f32 v78, v78
  v_exp_f32 v79, v79
  v_cvt_pk_bf16_f32 v124, v72, v73
  v_cvt_pk_bf16_f32 v125, v74, v75
  v_cvt_pk_bf16_f32 v126, v76, v77
  v_cvt_pk_bf16_f32 v127, v78, v79
  s_nop 1
  v_mfma_f32_32x32x16_bf16 v[96:111], v[138:141], v[124:127], v[96:111]
  ds_read_b128 v[138:141], v147 offset:672
  v_mov_b32 v142, v145
  v_mov_b32 v143, v146
  v_mov_b32 v144, v147
  s_mov_b32 s69, 0xffffac00
  s_cmp_eq_u32 s68, 0
  s_cselect_b32 s69, 0xa800, s69
  s_cmp_eq_u32 s68, 2
  s_cselect_b32 s69, 0xffffac00, s69
  v_add_u32 v145, s69, v145
  v_add_u32 v146, s69, v146
  v_add_u32 v147, s69, v147
  s_add_u32 s68, s68, 1
  s_cmp_eq_u32 s68, 3
  s_cselect_b32 s68, 0, s68
  s_add_u32 s71, s71, 1
  s_min_u32 s71, s71, s67
  s_add_u32 s70, s70, 1
  s_cmp_lt_u32 s70, 8
  s_cbranch_scc1 gated_mix__ssm_conv_h3__grouped_kv_mqa__prompt_kernel_loop
  s_setprio 0
  s_mov_b64 exec, 1
  ds_add_u32 v148, v149 offset:4
  s_mov_b64 exec, -1
  s_nop 15
  s_nop 7
  s_waitcnt lgkmcnt(0)
  v_mov_b32 v156, 161972
  s_mov_b32 s63, 0
gated_mix__ssm_conv_h3__grouped_kv_mqa__prompt_kernel_chksp:
  ds_read_b32 v157, v156
  s_waitcnt lgkmcnt(0)
  v_readfirstlane_b32 s69, v157
  s_nop 3
  s_cmp_ge_u32 s69, 1
  s_cbranch_scc1 gated_mix__ssm_conv_h3__grouped_kv_mqa__prompt_kernel_chksp_ok
  s_add_u32 s63, s63, 1
  s_cmp_gt_u32 s63, 1000000
  s_cbranch_scc1 gated_mix__ssm_conv_h3__grouped_kv_mqa__prompt_kernel_exit
  s_branch gated_mix__ssm_conv_h3__grouped_kv_mqa__prompt_kernel_chksp
gated_mix__ssm_conv_h3__grouped_kv_mqa__prompt_kernel_chksp_ok:
  ds_read_b32 v157, v156 offset:4
  s_waitcnt lgkmcnt(0)
  v_readfirstlane_b32 s69, v157
  s_nop 3
  s_cmp_lg_u32 s69, 0
  s_cbranch_scc1 gated_mix__ssm_conv_h3__grouped_kv_mqa__prompt_kernel_slow
gated_mix__ssm_conv_h3__grouped_kv_mqa__prompt_kernel_passok:
  v_mov_b32 v150, 161952
  v_mov_b32 v151, 1
  s_mov_b64 exec, 1
  ds_add_u32 v150, v151
  s_mov_b64 exec, -1
  s_cmp_lt_u32 s58, 6
  s_cbranch_scc1 gated_mix__ssm_conv_h3__grouped_kv_mqa__prompt_kernel_nos2
  s_sub_u32 s60, s67, 8
  s_mul_i32 s60, s60, 9
  s_add_u32 s60, s60, 56
  v_mov_b32 v150, 161884
  s_mov_b32 s63, 0
gated_mix__ssm_conv_h3__grouped_kv_mqa__prompt_kernel_s2sp:
  ds_read_b32 v151, v150
  s_waitcnt lgkmcnt(0)
  v_readfirstlane_b32 s69, v151
  s_nop 3
  s_cmp_ge_u32 s69, s60
  s_cbranch_scc1 gated_mix__ssm_conv_h3__grouped_kv_mqa__prompt_kernel_s2sp_ok
  s_add_u32 s63, s63, 1
  s_cmp_gt_u32 s63, 1000000
  s_cbranch_scc1 gated_mix__ssm_conv_h3__grouped_kv_mqa__prompt_kernel_exit
  s_branch gated_mix__ssm_conv_h3__grouped_kv_mqa__prompt_kernel_s2sp
gated_mix__ssm_conv_h3__grouped_kv_mqa__prompt_kernel_s2sp_ok:
gated_mix__ssm_conv_h3__grouped_kv_mqa__prompt_kernel_nos2:
  s_mul_i32 s60, s58, 2688
  s_add_u32 s61, s60, 144384
  s_add_u32 s62, s60, 101376
  s_cmp_lt_u32 s58, 6
  s_cselect_b32 s60, s61, s62
  s_xor_b32 s64, s58, 4
  s_mul_i32 s61, s64, 2688
  s_add_u32 s62, s61, 144384
  s_add_u32 s61, s61, 101376
  s_cmp_lt_u32 s64, 6
  s_cselect_b32 s61, s62, s61
  v_lshlrev_b32 v152, 4, v1
  v_add_u32 v150, s60, v152
  v_add_u32 v151, s61, v152
  s_cmp_lt_u32 s58, 4
  s_cbranch_scc1 gated_mix__ssm_conv_h3__grouped_kv_mqa__prompt_kernel_exlo
  ds_write_b128 v150, v[80:83]
  ds_write_b128 v150, v[84:87] offset:1024
  s_mov_b64 exec, 0xffffffff
  ds_write_b128 v150, v[88:91] offset:2048
  s_mov_b64 exec, -1
  v_lshrrev_b32 v153, 2, v152
  v_add_u32 v153, s60, v153
  s_mov_b32 exec_lo, 0
  ds_write_b32 v153, v88 offset:2432
  s_mov_b64 exec, -1
  s_waitcnt lgkmcnt(0)
  v_mov_b32 v80, v96
  v_mov_b32 v81, v97
  v_mov_b32 v82, v98
  v_mov_b32 v83, v99
  v_mov_b32 v84, v100
  v_mov_b32 v85, v101
  v_mov_b32 v86, v102
  v_mov_b32 v87, v103
  v_mov_b32 v88, v104
  v_mov_b32 v89, v105
  v_mov_b32 v90, v106
  v_mov_b32 v91, v107
  s_branch gated_mix__ssm_conv_h3__grouped_kv_mqa__prompt_kernel_exdone
gated_mix__ssm_conv_h3__grouped_kv_mqa__prompt_kernel_exlo:
  ds_write_b128 v150, v[96:99]
  ds_write_b128 v150, v[100:103] offset:1024
  s_mov_b64 exec, 0xffffffff
  ds_write_b128 v150, v[104:107] offset:2048
  s_mov_b64 exec, -1
  v_lshrrev_b32 v153, 2, v152
  v_add_u32 v153, s60, v153
  s_mov_b32 exec_lo, 0
  ds_write_b32 v153, v104 offset:2432
  s_mov_b64 exec, -1
  s_waitcnt lgkmcnt(0)
gated_mix__ssm_conv_h3__grouped_kv_mqa__prompt_kernel_exdone:
  s_lshl_b32 s62, s58, 2
  s_add_u32 s62, s62, 161920
  v_mov_b32 v153, s62
  v_mov_b32 v154, 1
  ds_write_b32 v153, v154
  s_lshl_b32 s62, s64, 2
  s_add_u32 s62, s62, 161920
  v_mov_b32 v153, s62
  s_mov_b32 s63, 0
gated_mix__ssm_conv_h3__grouped_kv_mqa__prompt_kernel_exsp:
  ds_read_b32 v154, v153
  s_waitcnt lgkmcnt(0)
  v_readfirstlane_b32 s69, v154
  s_nop 3
  s_add_u32 s63, s63, 1
  s_cmp_gt_u32 s63, 1000000
  s_cbranch_scc1 gated_mix__ssm_conv_h3__grouped_kv_mqa__prompt_kernel_exit
  s_cmp_eq_u32 s69, 0
  s_cbranch_scc1 gated_mix__ssm_conv_h3__grouped_kv_mqa__prompt_kernel_exsp
  ds_read_b128 v[96:99], v151
  ds_read_b128 v[100:103], v151 offset:1024
  ds_read_b128 v[104:107], v151 offset:2048
  v_lshrrev_b32 v153, 2, v152
  v_add_u32 v153, s61, v153
  ds_read_b32 v155, v153 offset:2432
  s_waitcnt lgkmcnt(0)
  v_cmp_eq_u32 vcc, 0, v3
  s_nop 1
  v_cndmask_b32 v104, v155, v104, vcc
  v_add_f32 v80, v80, v96
  v_add_f32 v81, v81, v97
  v_add_f32 v82, v82, v98
  v_add_f32 v83, v83, v99
  v_add_f32 v84, v84, v100
  v_add_f32 v85, v85, v101
  v_add_f32 v86, v86, v102
  v_add_f32 v87, v87, v103
  v_add_f32 v88, v88, v104
  v_add_f32 v89, v89, v105
  v_add_f32 v90, v90, v106
  v_add_f32 v91, v91, v107
  v_mov_b32 v152, v88
  v_mov_b32 v153, v88
  s_nop 1
  v_permlane32_swap_b32 v152, v153
  v_rcp_f32 v153, v153
  s_nop 0
  v_mul_f32 v80, v80, v153
  v_mul_f32 v81, v81, v153
  v_mul_f32 v82, v82, v153
  v_mul_f32 v83, v83, v153
  v_mul_f32 v84, v84, v153
  v_mul_f32 v85, v85, v153
  v_mul_f32 v86, v86, v153
  v_mul_f32 v87, v87, v153
  v_mul_f32 v88, v88, v153
  v_mul_f32 v89, v89, v153
  v_mul_f32 v90, v90, v153
  v_mul_f32 v91, v91, v153
  v_cvt_pk_bf16_f32 v80, v80, v81
  v_cvt_pk_bf16_f32 v81, v82, v83
  v_cvt_pk_bf16_f32 v82, v84, v85
  v_cvt_pk_bf16_f32 v83, v86, v87
  v_cvt_pk_bf16_f32 v84, v88, v89
  v_cvt_pk_bf16_f32 v85, v90, v91
  v_mov_b32 v156, 161956
  v_mov_b32 v157, 1
  s_mov_b64 exec, 1
  ds_add_u32 v156, v157
  s_mov_b64 exec, -1
  v_mov_b32 v156, 161968
  ds_read_b32 v157, v156
  s_lshr_b32 s60, s58, 2
  s_lshl_b32 s60, s60, 1
  v_lshrrev_b32 v150, 4, v2
  v_add_u32 v150, s60, v150
  v_mul_u32_u24 v150, 20480, v150
  v_and_b32 v151, 15, v2
  v_lshl_add_u32 v150, v151, 4, v150
  s_mul_i32 s60, s57, 20
  s_and_b32 s61, s58, 3
  s_mul_i32 s61, s61, 5
  s_add_u32 s60, s60, s61
  v_add_u32 v151, s60, v3
  v_lshrrev_b32 v154, 1, v151
  v_lshl_add_u32 v152, v154, 8, v150
  v_and_b32 v154, 1, v151
  v_lshl_add_u32 v152, v154, 3, v152
  v_add_u32 v151, 4, v151
  v_lshrrev_b32 v154, 1, v151
  v_lshl_add_u32 v153, v154, 8, v150
  v_and_b32 v154, 1, v151
  v_lshl_add_u32 v153, v154, 3, v153
  s_mul_i32 s61, s56, 81920
  s_add_u32 s61, s61, 2833408
  s_waitcnt lgkmcnt(0)
  v_readfirstlane_b32 s65, v157
  s_lshl_b32 s64, s56, 8
  s_lshl_b32 s60, s57, 5
  s_add_u32 s64, s64, s60
  s_lshl_b32 s60, s58, 2
  s_add_u32 s64, s64, s60
  s_add_u32 s64, s64, 11264
  s_cmp_eq_u32 s65, 0
  s_cbranch_scc1 gated_mix__ssm_conv_h3__grouped_kv_mqa__prompt_kernel_ost_s
  buffer_store_dwordx2 v[80:81], v152, s[16:19], s61 offen
  buffer_store_dwordx2 v[82:83], v152, s[16:19], s61 offen offset:256
  s_mov_b64 exec, 0xffffffff
  buffer_store_dwordx2 v[84:85], v153, s[16:19], s61 offen
  s_mov_b64 exec, 1
  v_mov_b32 v154, 0
  v_mov_b32 v155, s98
  s_waitcnt vmcnt(0)
  buffer_store_dword v155, v154, s[16:19], s64 offen
  s_mov_b64 exec, -1
  s_branch gated_mix__ssm_conv_h3__grouped_kv_mqa__prompt_kernel_ost_e
gated_mix__ssm_conv_h3__grouped_kv_mqa__prompt_kernel_ost_s:
  buffer_store_dwordx2 v[80:81], v152, s[16:19], s61 offen sc1
  buffer_store_dwordx2 v[82:83], v152, s[16:19], s61 offen offset:256 sc1
  s_mov_b64 exec, 0xffffffff
  buffer_store_dwordx2 v[84:85], v153, s[16:19], s61 offen sc1
  s_mov_b64 exec, 1
  v_mov_b32 v154, 0
  v_mov_b32 v155, s98
  s_waitcnt vmcnt(0)
  buffer_store_dword v155, v154, s[16:19], s64 offen sc1
  s_mov_b64 exec, -1
gated_mix__ssm_conv_h3__grouped_kv_mqa__prompt_kernel_ost_e:
  v_and_b32 v2, 15, v1
  v_bfe_u32 v3, v1, 4, 2
  s_and_b32 s59, s58, 3
  s_lshr_b32 s67, s58, 2
  v_lshrrev_b32 v13, 2, v2
  v_lshl_add_u32 v13, v3, 3, v13
  v_mul_u32_u24 v8, 192, v13
  v_and_b32 v13, 1, v3
  v_lshl_add_u32 v8, v13, 5, v8
  v_and_b32 v13, 3, v1
  v_lshl_add_u32 v8, v13, 3, v8
  v_add_u32 v9, 61440, v8
  v_mov_b32 v56, 0
  v_mov_b32 v57, 0
  v_mov_b32 v58, 0
  v_mov_b32 v59, 0
  v_mov_b32 v60, 0
  v_mov_b32 v61, 0
  v_mov_b32 v62, 0
  v_mov_b32 v63, 0
  v_mov_b32 v64, 0
  v_mov_b32 v65, 0
  v_mov_b32 v66, 0
  v_mov_b32 v67, 0
  v_mov_b32 v68, 0
  v_mov_b32 v69, 0
  v_mov_b32 v70, 0
  v_mov_b32 v71, 0
  v_mov_b32 v72, 0
  v_mov_b32 v73, 0
  v_mov_b32 v74, 0
  v_mov_b32 v75, 0
  s_lshl_b32 s60, s56, 6
  s_lshl_b32 s61, s59, 4
  s_add_u32 s60, s60, s61
  s_mul_i32 s65, s60, 1280
  s_mul_i32 s61, s57, 160
  s_add_u32 s65, s65, s61
  s_lshl_b32 s66, s60, 2
  s_add_u32 s66, s66, 203776
  v_mul_u32_u24 v10, 1280, v2
  v_lshl_add_u32 v10, v3, 3, v10
  v_lshlrev_b32 v11, 4, v1
  s_mul_i32 s62, s56, 81920
  s_mul_i32 s61, s59, 20480
  s_add_u32 s62, s62, s61
  s_mul_i32 s61, s67, 10240
  s_add_u32 s62, s62, s61
  s_add_u32 s62, s62, 2833408
  s_cmp_lg_u32 s67, 0
  s_cbranch_scc1 gated_mix__ssm_conv_h3__grouped_kv_mqa__prompt_kernel_noxq
  buffer_load_dwordx2 v[156:157], v10, s[4:7], s65 offen offset:0
  buffer_load_dwordx2 v[158:159], v10, s[4:7], s65 offen offset:32
  buffer_load_dwordx2 v[160:161], v10, s[4:7], s65 offen offset:64
  buffer_load_dwordx2 v[162:163], v10, s[4:7], s65 offen offset:96
  buffer_load_dwordx2 v[164:165], v10, s[4:7], s65 offen offset:128
  v_lshlrev_b32 v12, 2, v2
  buffer_load_dword v166, v12, s[16:19], s66 offen sc1
gated_mix__ssm_conv_h3__grouped_kv_mqa__prompt_kernel_noxq:
  s_cmp_lt_u32 s56, 16
  s_cselect_b32 s64, 4, 3
  s_cmp_eq_u32 s67, 0
  s_cbranch_scc1 gated_mix__ssm_conv_h3__grouped_kv_mqa__prompt_kernel_np1
  s_setprio 2
gated_mix__ssm_conv_h3__grouped_kv_mqa__prompt_kernel_np1:
  v_mov_b32 v13, 162080
  s_mov_b32 s63, 0
gated_mix__ssm_conv_h3__grouped_kv_mqa__prompt_kernel_woksp:
  ds_read_b32 v14, v13
  s_waitcnt lgkmcnt(0)
  v_readfirstlane_b32 s69, v14
  s_nop 3
  s_cmp_ge_u32 s69, s64
  s_cbranch_scc1 gated_mix__ssm_conv_h3__grouped_kv_mqa__prompt_kernel_woksp_ok
  s_add_u32 s63, s63, 1
  s_cmp_gt_u32 s63, 1000000
  s_cbranch_scc1 gated_mix__ssm_conv_h3__grouped_kv_mqa__prompt_kernel_exit
  s_branch gated_mix__ssm_conv_h3__grouped_kv_mqa__prompt_kernel_woksp
gated_mix__ssm_conv_h3__grouped_kv_mqa__prompt_kernel_woksp_ok:
  v_mov_b32 v13, 161956
  s_mov_b32 s63, 0
gated_mix__ssm_conv_h3__grouped_kv_mqa__prompt_kernel_stgsp2:
  ds_read_b32 v14, v13
  s_waitcnt lgkmcnt(0)
  v_readfirstlane_b32 s69, v14
  s_nop 3
  s_cmp_ge_u32 s69, 8
  s_cbranch_scc1 gated_mix__ssm_conv_h3__grouped_kv_mqa__prompt_kernel_stgsp2_ok
  s_add_u32 s63, s63, 1
  s_cmp_gt_u32 s63, 1000000
  s_cbranch_scc1 gated_mix__ssm_conv_h3__grouped_kv_mqa__prompt_kernel_exit
  s_branch gated_mix__ssm_conv_h3__grouped_kv_mqa__prompt_kernel_stgsp2
gated_mix__ssm_conv_h3__grouped_kv_mqa__prompt_kernel_stgsp2_ok:
  s_lshl_b32 s64, s56, 8
  s_lshl_b32 s60, s67, 7
  s_add_u32 s64, s64, s60
  s_lshr_b32 s60, s59, 1
  s_lshl_b32 s60, s60, 4
  s_add_u32 s64, s64, s60
  s_add_u32 s64, s64, 11264
  v_lshrrev_b32 v13, 2, v1
  v_lshlrev_b32 v13, 5, v13
  v_and_b32 v14, 3, v1
  v_lshl_add_u32 v13, v14, 2, v13
  s_cmp_lg_u32 s67, 0
  s_cbranch_scc1 gated_mix__ssm_conv_h3__grouped_kv_mqa__prompt_kernel_pc1
  ds_read_b64_tr_b16 v[76:77], v8 offset:43008
  ds_read_b64_tr_b16 v[78:79], v8 offset:43776
  ds_read_b64_tr_b16 v[80:81], v8 offset:43040
  ds_read_b64_tr_b16 v[82:83], v8 offset:43808
  ds_read_b64_tr_b16 v[84:85], v8 offset:43072
  ds_read_b64_tr_b16 v[86:87], v8 offset:43840
  ds_read_b64_tr_b16 v[88:89], v8 offset:43104
  ds_read_b64_tr_b16 v[90:91], v8 offset:43872
  ds_read_b64_tr_b16 v[92:93], v8 offset:43136
  ds_read_b64_tr_b16 v[94:95], v8 offset:43904
  ds_read_b64_tr_b16 v[96:97], v8 offset:49152
  ds_read_b64_tr_b16 v[98:99], v8 offset:49920
  ds_read_b64_tr_b16 v[100:101], v8 offset:49184
  ds_read_b64_tr_b16 v[102:103], v8 offset:49952
  ds_read_b64_tr_b16 v[104:105], v8 offset:49216
  ds_read_b64_tr_b16 v[106:107], v8 offset:49984
  ds_read_b64_tr_b16 v[108:109], v8 offset:49248
  ds_read_b64_tr_b16 v[110:111], v8 offset:50016
  ds_read_b64_tr_b16 v[112:113], v8 offset:49280
  ds_read_b64_tr_b16 v[114:115], v8 offset:50048
  ds_read_b64_tr_b16 v[116:117], v8 offset:55296
  ds_read_b64_tr_b16 v[118:119], v8 offset:56064
  ds_read_b64_tr_b16 v[120:121], v8 offset:55328
  ds_read_b64_tr_b16 v[122:123], v8 offset:56096
  ds_read_b64_tr_b16 v[124:125], v8 offset:55360
  ds_read_b64_tr_b16 v[126:127], v8 offset:56128
  ds_read_b64_tr_b16 v[128:129], v8 offset:55392
  ds_read_b64_tr_b16 v[130:131], v8 offset:56160
  ds_read_b64_tr_b16 v[132:133], v8 offset:55424
  ds_read_b64_tr_b16 v[134:135], v8 offset:56192
  ds_read_b64_tr_b16 v[136:137], v8 offset:0
  ds_read_b64_tr_b16 v[138:139], v8 offset:768
  ds_read_b64_tr_b16 v[140:141], v8 offset:32
  ds_read_b64_tr_b16 v[142:143], v8 offset:800
  ds_read_b64_tr_b16 v[144:145], v8 offset:64
  ds_read_b64_tr_b16 v[146:147], v8 offset:832
  ds_read_b64_tr_b16 v[148:149], v8 offset:96
  ds_read_b64_tr_b16 v[150:151], v8 offset:864
  ds_read_b64_tr_b16 v[152:153], v8 offset:128
  ds_read_b64_tr_b16 v[154:155], v8 offset:896
  v_mov_b32 v13, 161960
  s_mov_b32 s63, 0
gated_mix__ssm_conv_h3__grouped_kv_mqa__prompt_kernel_gosp0:
  ds_read_b32 v14, v13
  s_waitcnt lgkmcnt(0)
  v_readfirstlane_b32 s69, v14
  s_nop 3
  s_cmp_ge_u32 s69, 1
  s_cbranch_scc1 gated_mix__ssm_conv_h3__grouped_kv_mqa__prompt_kernel_gosp0_ok
  s_add_u32 s63, s63, 1
  s_cmp_gt_u32 s63, 1000000
  s_cbranch_scc1 gated_mix__ssm_conv_h3__grouped_kv_mqa__prompt_kernel_exit
  s_branch gated_mix__ssm_conv_h3__grouped_kv_mqa__prompt_kernel_gosp0
gated_mix__ssm_conv_h3__grouped_kv_mqa__prompt_kernel_gosp0_ok:
  s_add_u32 s61, s62, 7168
  buffer_load_dwordx4 v[16:19], v11, s[16:19], s61 offen sc1
  s_add_u32 s61, s62, 8192
  buffer_load_dwordx4 v[20:23], v11, s[16:19], s61 offen sc1
  s_add_u32 s61, s62, 9216
  buffer_load_dwordx4 v[24:27], v11, s[16:19], s61 offen sc1
  s_add_u32 s61, s62, 0
  buffer_load_dwordx4 v[28:31], v11, s[16:19], s61 offen sc1
  s_add_u32 s61, s62, 1024
  buffer_load_dwordx4 v[32:35], v11, s[16:19], s61 offen sc1
  s_add_u32 s61, s62, 2048
  buffer_load_dwordx4 v[36:39], v11, s[16:19], s61 offen sc1
  s_add_u32 s61, s62, 3072
  buffer_load_dwordx4 v[40:43], v11, s[16:19], s61 offen sc1
  s_add_u32 s61, s62, 4096
  buffer_load_dwordx4 v[44:47], v11, s[16:19], s61 offen sc1
  s_add_u32 s61, s62, 5120
  buffer_load_dwordx4 v[48:51], v11, s[16:19], s61 offen sc1
  s_add_u32 s61, s62, 6144
  buffer_load_dwordx4 v[52:55], v11, s[16:19], s61 offen sc1
  s_waitcnt lgkmcnt(0)
  s_waitcnt vmcnt(9)
  v_mfma_f32_16x16x32_bf16 v[56:59], v[76:79], v[16:19], v[56:59]
  v_mfma_f32_16x16x32_bf16 v[60:63], v[80:83], v[16:19], v[60:63]
  v_mfma_f32_16x16x32_bf16 v[64:67], v[84:87], v[16:19], v[64:67]
  v_mfma_f32_16x16x32_bf16 v[68:71], v[88:91], v[16:19], v[68:71]
  v_mfma_f32_16x16x32_bf16 v[72:75], v[92:95], v[16:19], v[72:75]
  s_waitcnt vmcnt(8)
  v_mfma_f32_16x16x32_bf16 v[56:59], v[96:99], v[20:23], v[56:59]
  ds_read_b64_tr_b16 v[76:77], v8 offset:6144
  ds_read_b64_tr_b16 v[78:79], v8 offset:6912
  v_mfma_f32_16x16x32_bf16 v[60:63], v[100:103], v[20:23], v[60:63]
  ds_read_b64_tr_b16 v[80:81], v8 offset:6176
  ds_read_b64_tr_b16 v[82:83], v8 offset:6944
  v_mfma_f32_16x16x32_bf16 v[64:67], v[104:107], v[20:23], v[64:67]
  ds_read_b64_tr_b16 v[84:85], v8 offset:6208
  ds_read_b64_tr_b16 v[86:87], v8 offset:6976
  v_mfma_f32_16x16x32_bf16 v[68:71], v[108:111], v[20:23], v[68:71]
  ds_read_b64_tr_b16 v[88:89], v8 offset:6240
  ds_read_b64_tr_b16 v[90:91], v8 offset:7008
  v_mfma_f32_16x16x32_bf16 v[72:75], v[112:115], v[20:23], v[72:75]
  ds_read_b64_tr_b16 v[92:93], v8 offset:6272
  ds_read_b64_tr_b16 v[94:95], v8 offset:7040
  s_waitcnt vmcnt(7)
  v_mfma_f32_16x16x32_bf16 v[56:59], v[116:119], v[24:27], v[56:59]
  ds_read_b64_tr_b16 v[96:97], v8 offset:12288
  ds_read_b64_tr_b16 v[98:99], v8 offset:13056
  v_mfma_f32_16x16x32_bf16 v[60:63], v[120:123], v[24:27], v[60:63]
  ds_read_b64_tr_b16 v[100:101], v8 offset:12320
  ds_read_b64_tr_b16 v[102:103], v8 offset:13088
  v_mfma_f32_16x16x32_bf16 v[64:67], v[124:127], v[24:27], v[64:67]
  ds_read_b64_tr_b16 v[104:105], v8 offset:12352
  ds_read_b64_tr_b16 v[106:107], v8 offset:13120
  v_mfma_f32_16x16x32_bf16 v[68:71], v[128:131], v[24:27], v[68:71]
  ds_read_b64_tr_b16 v[108:109], v8 offset:12384
  ds_read_b64_tr_b16 v[110:111], v8 offset:13152
  v_mfma_f32_16x16x32_bf16 v[72:75], v[132:135], v[24:27], v[72:75]
  ds_read_b64_tr_b16 v[112:113], v8 offset:12416
  ds_read_b64_tr_b16 v[114:115], v8 offset:13184
  s_waitcnt vmcnt(6)
  v_mfma_f32_16x16x32_bf16 v[56:59], v[136:139], v[28:31], v[56:59]
  ds_read_b64_tr_b16 v[116:117], v8 offset:18432
  ds_read_b64_tr_b16 v[118:119], v8 offset:19200
  v_mfma_f32_16x16x32_bf16 v[60:63], v[140:143], v[28:31], v[60:63]
  ds_read_b64_tr_b16 v[120:121], v8 offset:18464
  ds_read_b64_tr_b16 v[122:123], v8 offset:19232
  v_mfma_f32_16x16x32_bf16 v[64:67], v[144:147], v[28:31], v[64:67]
  ds_read_b64_tr_b16 v[124:125], v8 offset:18496
  ds_read_b64_tr_b16 v[126:127], v8 offset:19264
  v_mfma_f32_16x16x32_bf16 v[68:71], v[148:151], v[28:31], v[68:71]
  ds_read_b64_tr_b16 v[128:129], v8 offset:18528
  ds_read_b64_tr_b16 v[130:131], v8 offset:19296
  v_mfma_f32_16x16x32_bf16 v[72:75], v[152:155], v[28:31], v[72:75]
  ds_read_b64_tr_b16 v[132:133], v8 offset:18560
  ds_read_b64_tr_b16 v[134:135], v8 offset:19328
  s_waitcnt vmcnt(5) lgkmcnt(15)
  v_mfma_f32_16x16x32_bf16 v[56:59], v[76:79], v[32:35], v[56:59]
  ds_read_b64_tr_b16 v[136:137], v8 offset:24576
  ds_read_b64_tr_b16 v[138:139], v8 offset:25344
  v_mfma_f32_16x16x32_bf16 v[60:63], v[80:83], v[32:35], v[60:63]
  ds_read_b64_tr_b16 v[140:141], v8 offset:24608
  ds_read_b64_tr_b16 v[142:143], v8 offset:25376
  v_mfma_f32_16x16x32_bf16 v[64:67], v[84:87], v[32:35], v[64:67]
  ds_read_b64_tr_b16 v[144:145], v8 offset:24640
  ds_read_b64_tr_b16 v[146:147], v8 offset:25408
  v_mfma_f32_16x16x32_bf16 v[68:71], v[88:91], v[32:35], v[68:71]
  ds_read_b64_tr_b16 v[148:149], v8 offset:24672
  ds_read_b64_tr_b16 v[150:151], v8 offset:25440
  v_mfma_f32_16x16x32_bf16 v[72:75], v[92:95], v[32:35], v[72:75]
  ds_read_b64_tr_b16 v[152:153], v8 offset:24704
  ds_read_b64_tr_b16 v[154:155], v8 offset:25472
  s_waitcnt vmcnt(4) lgkmcnt(15)
  v_mfma_f32_16x16x32_bf16 v[56:59], v[96:99], v[36:39], v[56:59]
  ds_read_b64_tr_b16 v[76:77], v8 offset:30720
  ds_read_b64_tr_b16 v[78:79], v8 offset:31488
  v_mfma_f32_16x16x32_bf16 v[60:63], v[100:103], v[36:39], v[60:63]
  ds_read_b64_tr_b16 v[80:81], v8 offset:30752
  ds_read_b64_tr_b16 v[82:83], v8 offset:31520
  v_mfma_f32_16x16x32_bf16 v[64:67], v[104:107], v[36:39], v[64:67]
  ds_read_b64_tr_b16 v[84:85], v8 offset:30784
  ds_read_b64_tr_b16 v[86:87], v8 offset:31552
  v_mfma_f32_16x16x32_bf16 v[68:71], v[108:111], v[36:39], v[68:71]
  ds_read_b64_tr_b16 v[88:89], v8 offset:30816
  ds_read_b64_tr_b16 v[90:91], v8 offset:31584
  v_mfma_f32_16x16x32_bf16 v[72:75], v[112:115], v[36:39], v[72:75]
  ds_read_b64_tr_b16 v[92:93], v8 offset:30848
  ds_read_b64_tr_b16 v[94:95], v8 offset:31616
  s_waitcnt vmcnt(3) lgkmcnt(15)
  v_mfma_f32_16x16x32_bf16 v[56:59], v[116:119], v[40:43], v[56:59]
  ds_read_b64_tr_b16 v[96:97], v8 offset:36864
  ds_read_b64_tr_b16 v[98:99], v8 offset:37632
  v_mfma_f32_16x16x32_bf16 v[60:63], v[120:123], v[40:43], v[60:63]
  ds_read_b64_tr_b16 v[100:101], v8 offset:36896
  ds_read_b64_tr_b16 v[102:103], v8 offset:37664
  v_mfma_f32_16x16x32_bf16 v[64:67], v[124:127], v[40:43], v[64:67]
  ds_read_b64_tr_b16 v[104:105], v8 offset:36928
  ds_read_b64_tr_b16 v[106:107], v8 offset:37696
  v_mfma_f32_16x16x32_bf16 v[68:71], v[128:131], v[40:43], v[68:71]
  ds_read_b64_tr_b16 v[108:109], v8 offset:36960
  ds_read_b64_tr_b16 v[110:111], v8 offset:37728
  v_mfma_f32_16x16x32_bf16 v[72:75], v[132:135], v[40:43], v[72:75]
  ds_read_b64_tr_b16 v[112:113], v8 offset:36992
  ds_read_b64_tr_b16 v[114:115], v8 offset:37760
  s_waitcnt vmcnt(2) lgkmcnt(15)
  v_mfma_f32_16x16x32_bf16 v[56:59], v[136:139], v[44:47], v[56:59]
  v_mfma_f32_16x16x32_bf16 v[60:63], v[140:143], v[44:47], v[60:63]
  v_mfma_f32_16x16x32_bf16 v[64:67], v[144:147], v[44:47], v[64:67]
  v_mfma_f32_16x16x32_bf16 v[68:71], v[148:151], v[44:47], v[68:71]
  v_mfma_f32_16x16x32_bf16 v[72:75], v[152:155], v[44:47], v[72:75]
  s_waitcnt vmcnt(1) lgkmcnt(10)
  v_mfma_f32_16x16x32_bf16 v[56:59], v[76:79], v[48:51], v[56:59]
  v_mfma_f32_16x16x32_bf16 v[60:63], v[80:83], v[48:51], v[60:63]
  v_mfma_f32_16x16x32_bf16 v[64:67], v[84:87], v[48:51], v[64:67]
  v_mfma_f32_16x16x32_bf16 v[68:71], v[88:91], v[48:51], v[68:71]
  v_mfma_f32_16x16x32_bf16 v[72:75], v[92:95], v[48:51], v[72:75]
  s_waitcnt vmcnt(0) lgkmcnt(0)
  v_mfma_f32_16x16x32_bf16 v[56:59], v[96:99], v[52:55], v[56:59]
  v_mfma_f32_16x16x32_bf16 v[60:63], v[100:103], v[52:55], v[60:63]
  v_mfma_f32_16x16x32_bf16 v[64:67], v[104:107], v[52:55], v[64:67]
  v_mfma_f32_16x16x32_bf16 v[68:71], v[108:111], v[52:55], v[68:71]
  v_mfma_f32_16x16x32_bf16 v[72:75], v[112:115], v[52:55], v[72:75]
  s_branch gated_mix__ssm_conv_h3__grouped_kv_mqa__prompt_kernel_pc2
gated_mix__ssm_conv_h3__grouped_kv_mqa__prompt_kernel_pc1:
  ds_read_b64_tr_b16 v[76:77], v8 offset:61440
  ds_read_b64_tr_b16 v[78:79], v8 offset:62208
  ds_read_b64_tr_b16 v[80:81], v8 offset:61472
  ds_read_b64_tr_b16 v[82:83], v8 offset:62240
  ds_read_b64_tr_b16 v[84:85], v8 offset:61504
  ds_read_b64_tr_b16 v[86:87], v8 offset:62272
  ds_read_b64_tr_b16 v[88:89], v8 offset:61536
  ds_read_b64_tr_b16 v[90:91], v8 offset:62304
  ds_read_b64_tr_b16 v[92:93], v8 offset:61568
  ds_read_b64_tr_b16 v[94:95], v8 offset:62336
  ds_read_b64_tr_b16 v[96:97], v9 offset:6144
  ds_read_b64_tr_b16 v[98:99], v9 offset:6912
  ds_read_b64_tr_b16 v[100:101], v9 offset:6176
  ds_read_b64_tr_b16 v[102:103], v9 offset:6944
  ds_read_b64_tr_b16 v[104:105], v9 offset:6208
  ds_read_b64_tr_b16 v[106:107], v9 offset:6976
  ds_read_b64_tr_b16 v[108:109], v9 offset:6240
  ds_read_b64_tr_b16 v[110:111], v9 offset:7008
  ds_read_b64_tr_b16 v[112:113], v9 offset:6272
  ds_read_b64_tr_b16 v[114:115], v9 offset:7040
  ds_read_b64_tr_b16 v[116:117], v9 offset:12288
  ds_read_b64_tr_b16 v[118:119], v9 offset:13056
  ds_read_b64_tr_b16 v[120:121], v9 offset:12320
  ds_read_b64_tr_b16 v[122:123], v9 offset:13088
  ds_read_b64_tr_b16 v[124:125], v9 offset:12352
  ds_read_b64_tr_b16 v[126:127], v9 offset:13120
  ds_read_b64_tr_b16 v[128:129], v9 offset:12384
  ds_read_b64_tr_b16 v[130:131], v9 offset:13152
  ds_read_b64_tr_b16 v[132:133], v9 offset:12416
  ds_read_b64_tr_b16 v[134:135], v9 offset:13184
  ds_read_b64_tr_b16 v[136:137], v9 offset:18432
  ds_read_b64_tr_b16 v[138:139], v9 offset:19200
  ds_read_b64_tr_b16 v[140:141], v9 offset:18464
  ds_read_b64_tr_b16 v[142:143], v9 offset:19232
  ds_read_b64_tr_b16 v[144:145], v9 offset:18496
  ds_read_b64_tr_b16 v[146:147], v9 offset:19264
  ds_read_b64_tr_b16 v[148:149], v9 offset:18528
  ds_read_b64_tr_b16 v[150:151], v9 offset:19296
  ds_read_b64_tr_b16 v[152:153], v9 offset:18560
  ds_read_b64_tr_b16 v[154:155], v9 offset:19328
  v_mov_b32 v13, 161960
  s_mov_b32 s63, 0
gated_mix__ssm_conv_h3__grouped_kv_mqa__prompt_kernel_gosp1:
  ds_read_b32 v14, v13
  s_waitcnt lgkmcnt(0)
  v_readfirstlane_b32 s69, v14
  s_nop 3
  s_cmp_ge_u32 s69, 1
  s_cbranch_scc1 gated_mix__ssm_conv_h3__grouped_kv_mqa__prompt_kernel_gosp1_ok
  s_add_u32 s63, s63, 1
  s_cmp_gt_u32 s63, 1000000
  s_cbranch_scc1 gated_mix__ssm_conv_h3__grouped_kv_mqa__prompt_kernel_exit
  s_branch gated_mix__ssm_conv_h3__grouped_kv_mqa__prompt_kernel_gosp1
gated_mix__ssm_conv_h3__grouped_kv_mqa__prompt_kernel_gosp1_ok:
  s_add_u32 s61, s62, 0
  buffer_load_dwordx4 v[16:19], v11, s[16:19], s61 offen sc1
  s_add_u32 s61, s62, 1024
  buffer_load_dwordx4 v[20:23], v11, s[16:19], s61 offen sc1
  s_add_u32 s61, s62, 2048
  buffer_load_dwordx4 v[24:27], v11, s[16:19], s61 offen sc1
  s_add_u32 s61, s62, 3072
  buffer_load_dwordx4 v[28:31], v11, s[16:19], s61 offen sc1
  s_add_u32 s61, s62, 4096
  buffer_load_dwordx4 v[32:35], v11, s[16:19], s61 offen sc1
  s_add_u32 s61, s62, 5120
  buffer_load_dwordx4 v[36:39], v11, s[16:19], s61 offen sc1
  s_add_u32 s61, s62, 6144
  buffer_load_dwordx4 v[40:43], v11, s[16:19], s61 offen sc1
  s_add_u32 s61, s62, 7168
  buffer_load_dwordx4 v[44:47], v11, s[16:19], s61 offen sc1
  s_add_u32 s61, s62, 8192
  buffer_load_dwordx4 v[48:51], v11, s[16:19], s61 offen sc1
  s_add_u32 s61, s62, 9216
  buffer_load_dwordx4 v[52:55], v11, s[16:19], s61 offen sc1
  s_waitcnt lgkmcnt(0)
  s_waitcnt vmcnt(9)
  v_mfma_f32_16x16x32_bf16 v[56:59], v[76:79], v[16:19], v[56:59]
  v_mfma_f32_16x16x32_bf16 v[60:63], v[80:83], v[16:19], v[60:63]
  v_mfma_f32_16x16x32_bf16 v[64:67], v[84:87], v[16:19], v[64:67]
  v_mfma_f32_16x16x32_bf16 v[68:71], v[88:91], v[16:19], v[68:71]
  v_mfma_f32_16x16x32_bf16 v[72:75], v[92:95], v[16:19], v[72:75]
  s_waitcnt vmcnt(8)
  v_mfma_f32_16x16x32_bf16 v[56:59], v[96:99], v[20:23], v[56:59]
  ds_read_b64_tr_b16 v[76:77], v9 offset:24576
  ds_read_b64_tr_b16 v[78:79], v9 offset:25344
  v_mfma_f32_16x16x32_bf16 v[60:63], v[100:103], v[20:23], v[60:63]
  ds_read_b64_tr_b16 v[80:81], v9 offset:24608
  ds_read_b64_tr_b16 v[82:83], v9 offset:25376
  v_mfma_f32_16x16x32_bf16 v[64:67], v[104:107], v[20:23], v[64:67]
  ds_read_b64_tr_b16 v[84:85], v9 offset:24640
  ds_read_b64_tr_b16 v[86:87], v9 offset:25408
  v_mfma_f32_16x16x32_bf16 v[68:71], v[108:111], v[20:23], v[68:71]
  ds_read_b64_tr_b16 v[88:89], v9 offset:24672
  ds_read_b64_tr_b16 v[90:91], v9 offset:25440
  v_mfma_f32_16x16x32_bf16 v[72:75], v[112:115], v[20:23], v[72:75]
  ds_read_b64_tr_b16 v[92:93], v9 offset:24704
  ds_read_b64_tr_b16 v[94:95], v9 offset:25472
  s_waitcnt vmcnt(7)
  v_mfma_f32_16x16x32_bf16 v[56:59], v[116:119], v[24:27], v[56:59]
  ds_read_b64_tr_b16 v[96:97], v9 offset:30720
  ds_read_b64_tr_b16 v[98:99], v9 offset:31488
  v_mfma_f32_16x16x32_bf16 v[60:63], v[120:123], v[24:27], v[60:63]
  ds_read_b64_tr_b16 v[100:101], v9 offset:30752
  ds_read_b64_tr_b16 v[102:103], v9 offset:31520
  v_mfma_f32_16x16x32_bf16 v[64:67], v[124:127], v[24:27], v[64:67]
  ds_read_b64_tr_b16 v[104:105], v9 offset:30784
  ds_read_b64_tr_b16 v[106:107], v9 offset:31552
  v_mfma_f32_16x16x32_bf16 v[68:71], v[128:131], v[24:27], v[68:71]
  ds_read_b64_tr_b16 v[108:109], v9 offset:30816
  ds_read_b64_tr_b16 v[110:111], v9 offset:31584
  v_mfma_f32_16x16x32_bf16 v[72:75], v[132:135], v[24:27], v[72:75]
  ds_read_b64_tr_b16 v[112:113], v9 offset:30848
  ds_read_b64_tr_b16 v[114:115], v9 offset:31616
  s_waitcnt vmcnt(6)
  v_mfma_f32_16x16x32_bf16 v[56:59], v[136:139], v[28:31], v[56:59]
  ds_read_b64_tr_b16 v[116:117], v9 offset:36864
  ds_read_b64_tr_b16 v[118:119], v9 offset:37632
  v_mfma_f32_16x16x32_bf16 v[60:63], v[140:143], v[28:31], v[60:63]
  ds_read_b64_tr_b16 v[120:121], v9 offset:36896
  ds_read_b64_tr_b16 v[122:123], v9 offset:37664
  v_mfma_f32_16x16x32_bf16 v[64:67], v[144:147], v[28:31], v[64:67]
  ds_read_b64_tr_b16 v[124:125], v9 offset:36928
  ds_read_b64_tr_b16 v[126:127], v9 offset:37696
  v_mfma_f32_16x16x32_bf16 v[68:71], v[148:151], v[28:31], v[68:71]
  ds_read_b64_tr_b16 v[128:129], v9 offset:36960
  ds_read_b64_tr_b16 v[130:131], v9 offset:37728
  v_mfma_f32_16x16x32_bf16 v[72:75], v[152:155], v[28:31], v[72:75]
  ds_read_b64_tr_b16 v[132:133], v9 offset:36992
  ds_read_b64_tr_b16 v[134:135], v9 offset:37760
  s_waitcnt vmcnt(5) lgkmcnt(15)
  v_mfma_f32_16x16x32_bf16 v[56:59], v[76:79], v[32:35], v[56:59]
  ds_read_b64_tr_b16 v[136:137], v9 offset:43008
  ds_read_b64_tr_b16 v[138:139], v9 offset:43776
  v_mfma_f32_16x16x32_bf16 v[60:63], v[80:83], v[32:35], v[60:63]
  ds_read_b64_tr_b16 v[140:141], v9 offset:43040
  ds_read_b64_tr_b16 v[142:143], v9 offset:43808
  v_mfma_f32_16x16x32_bf16 v[64:67], v[84:87], v[32:35], v[64:67]
  ds_read_b64_tr_b16 v[144:145], v9 offset:43072
  ds_read_b64_tr_b16 v[146:147], v9 offset:43840
  v_mfma_f32_16x16x32_bf16 v[68:71], v[88:91], v[32:35], v[68:71]
  ds_read_b64_tr_b16 v[148:149], v9 offset:43104
  ds_read_b64_tr_b16 v[150:151], v9 offset:43872
  v_mfma_f32_16x16x32_bf16 v[72:75], v[92:95], v[32:35], v[72:75]
  ds_read_b64_tr_b16 v[152:153], v9 offset:43136
  ds_read_b64_tr_b16 v[154:155], v9 offset:43904
  s_waitcnt vmcnt(4) lgkmcnt(15)
  v_mfma_f32_16x16x32_bf16 v[56:59], v[96:99], v[36:39], v[56:59]
  ds_read_b64_tr_b16 v[76:77], v9 offset:49152
  ds_read_b64_tr_b16 v[78:79], v9 offset:49920
  v_mfma_f32_16x16x32_bf16 v[60:63], v[100:103], v[36:39], v[60:63]
  ds_read_b64_tr_b16 v[80:81], v9 offset:49184
  ds_read_b64_tr_b16 v[82:83], v9 offset:49952
  v_mfma_f32_16x16x32_bf16 v[64:67], v[104:107], v[36:39], v[64:67]
  ds_read_b64_tr_b16 v[84:85], v9 offset:49216
  ds_read_b64_tr_b16 v[86:87], v9 offset:49984
  v_mfma_f32_16x16x32_bf16 v[68:71], v[108:111], v[36:39], v[68:71]
  ds_read_b64_tr_b16 v[88:89], v9 offset:49248
  ds_read_b64_tr_b16 v[90:91], v9 offset:50016
  v_mfma_f32_16x16x32_bf16 v[72:75], v[112:115], v[36:39], v[72:75]
  ds_read_b64_tr_b16 v[92:93], v9 offset:49280
  ds_read_b64_tr_b16 v[94:95], v9 offset:50048
  s_waitcnt vmcnt(3) lgkmcnt(15)
  v_mfma_f32_16x16x32_bf16 v[56:59], v[116:119], v[40:43], v[56:59]
  ds_read_b64_tr_b16 v[96:97], v9 offset:55296
  ds_read_b64_tr_b16 v[98:99], v9 offset:56064
  v_mfma_f32_16x16x32_bf16 v[60:63], v[120:123], v[40:43], v[60:63]
  ds_read_b64_tr_b16 v[100:101], v9 offset:55328
  ds_read_b64_tr_b16 v[102:103], v9 offset:56096
  v_mfma_f32_16x16x32_bf16 v[64:67], v[124:127], v[40:43], v[64:67]
  ds_read_b64_tr_b16 v[104:105], v9 offset:55360
  ds_read_b64_tr_b16 v[106:107], v9 offset:56128
  v_mfma_f32_16x16x32_bf16 v[68:71], v[128:131], v[40:43], v[68:71]
  ds_read_b64_tr_b16 v[108:109], v9 offset:55392
  ds_read_b64_tr_b16 v[110:111], v9 offset:56160
  v_mfma_f32_16x16x32_bf16 v[72:75], v[132:135], v[40:43], v[72:75]
  ds_read_b64_tr_b16 v[112:113], v9 offset:55424
  ds_read_b64_tr_b16 v[114:115], v9 offset:56192
  s_waitcnt vmcnt(2) lgkmcnt(15)
  v_mfma_f32_16x16x32_bf16 v[56:59], v[136:139], v[44:47], v[56:59]
  v_mfma_f32_16x16x32_bf16 v[60:63], v[140:143], v[44:47], v[60:63]
  v_mfma_f32_16x16x32_bf16 v[64:67], v[144:147], v[44:47], v[64:67]
  v_mfma_f32_16x16x32_bf16 v[68:71], v[148:151], v[44:47], v[68:71]
  v_mfma_f32_16x16x32_bf16 v[72:75], v[152:155], v[44:47], v[72:75]
  s_waitcnt vmcnt(1) lgkmcnt(10)
  v_mfma_f32_16x16x32_bf16 v[56:59], v[76:79], v[48:51], v[56:59]
  v_mfma_f32_16x16x32_bf16 v[60:63], v[80:83], v[48:51], v[60:63]
  v_mfma_f32_16x16x32_bf16 v[64:67], v[84:87], v[48:51], v[64:67]
  v_mfma_f32_16x16x32_bf16 v[68:71], v[88:91], v[48:51], v[68:71]
  v_mfma_f32_16x16x32_bf16 v[72:75], v[92:95], v[48:51], v[72:75]
  s_waitcnt vmcnt(0) lgkmcnt(0)
  v_mfma_f32_16x16x32_bf16 v[56:59], v[96:99], v[52:55], v[56:59]
  v_mfma_f32_16x16x32_bf16 v[60:63], v[100:103], v[52:55], v[60:63]
  v_mfma_f32_16x16x32_bf16 v[64:67], v[104:107], v[52:55], v[64:67]
  v_mfma_f32_16x16x32_bf16 v[68:71], v[108:111], v[52:55], v[68:71]
  v_mfma_f32_16x16x32_bf16 v[72:75], v[112:115], v[52:55], v[72:75]
  s_mul_i32 s60, s59, 5120
  s_add_u32 s60, s60, 133120
  v_add_u32 v13, s60, v11
  s_nop 7
  ds_write_b128 v13, v[56:59] offset:0
  ds_write_b128 v13, v[60:63] offset:1024
  ds_write_b128 v13, v[64:67] offset:2048
  ds_write_b128 v13, v[68:71] offset:3072
  ds_write_b128 v13, v[72:75] offset:4096
  s_waitcnt lgkmcnt(0)
  s_lshl_b32 s60, s59, 2
  s_add_u32 s60, s60, 162032
  v_mov_b32 v13, s60
  v_mov_b32 v14, 1
  s_mov_b64 exec, 1
  ds_add_u32 v13, v14
  s_mov_b64 exec, -1
  s_waitcnt lgkmcnt(0)
  s_branch gated_mix__ssm_conv_h3__grouped_kv_mqa__prompt_kernel_exit
gated_mix__ssm_conv_h3__grouped_kv_mqa__prompt_kernel_pc2:
  v_mov_b32 v14, 161964
  s_mov_b32 s63, 0
gated_mix__ssm_conv_h3__grouped_kv_mqa__prompt_kernel_yoksp:
  ds_read_b32 v15, v14
  s_waitcnt lgkmcnt(0)
  v_readfirstlane_b32 s69, v15
  s_nop 3
  s_cmp_ge_u32 s69, 1
  s_cbranch_scc1 gated_mix__ssm_conv_h3__grouped_kv_mqa__prompt_kernel_yoksp_ok
  s_add_u32 s63, s63, 1
  s_cmp_gt_u32 s63, 1000000
  s_cbranch_scc1 gated_mix__ssm_conv_h3__grouped_kv_mqa__prompt_kernel_exit
  s_branch gated_mix__ssm_conv_h3__grouped_kv_mqa__prompt_kernel_yoksp
gated_mix__ssm_conv_h3__grouped_kv_mqa__prompt_kernel_yoksp_ok:
  v_lshrrev_b32 v13, 2, v2
  v_lshl_add_u32 v13, v3, 2, v13
  v_lshlrev_b32 v13, 7, v13
  v_and_b32 v14, 3, v1
  v_lshl_add_u32 v13, v14, 3, v13
  s_lshl_b32 s60, s59, 5
  s_add_u32 s60, s60, 122880
  v_add_u32 v13, s60, v13
  ds_read_b64_tr_b16 v[96:97], v13 offset:0
  ds_read_b64_tr_b16 v[98:99], v13 offset:2048
  ds_read_b64_tr_b16 v[100:101], v13 offset:4096
  ds_read_b64_tr_b16 v[102:103], v13 offset:6144
  ds_read_b64_tr_b16 v[104:105], v13 offset:8192
  s_waitcnt vmcnt(0) lgkmcnt(0)
  v_sub_f32 v167, 1.0, v166
  v_lshlrev_b32 v108, 16, v156
  v_lshlrev_b32 v130, 16, v96
  v_mul_f32 v108, v108, v130
  v_mul_f32 v108, v108, v166
  v_and_b32 v109, 0xffff0000, v156
  v_and_b32 v130, 0xffff0000, v96
  v_mul_f32 v109, v109, v130
  v_mul_f32 v109, v109, v166
  v_lshlrev_b32 v110, 16, v157
  v_lshlrev_b32 v130, 16, v97
  v_mul_f32 v110, v110, v130
  v_mul_f32 v110, v110, v166
  v_and_b32 v111, 0xffff0000, v157
  v_and_b32 v130, 0xffff0000, v97
  v_mul_f32 v111, v111, v130
  v_mul_f32 v111, v111, v166
  v_lshlrev_b32 v112, 16, v158
  v_lshlrev_b32 v130, 16, v98
  v_mul_f32 v112, v112, v130
  v_mul_f32 v112, v112, v166
  v_and_b32 v113, 0xffff0000, v158
  v_and_b32 v130, 0xffff0000, v98
  v_mul_f32 v113, v113, v130
  v_mul_f32 v113, v113, v166
  v_lshlrev_b32 v114, 16, v159
  v_lshlrev_b32 v130, 16, v99
  v_mul_f32 v114, v114, v130
  v_mul_f32 v114, v114, v166
  v_and_b32 v115, 0xffff0000, v159
  v_and_b32 v130, 0xffff0000, v99
  v_mul_f32 v115, v115, v130
  v_mul_f32 v115, v115, v166
  v_lshlrev_b32 v116, 16, v160
  v_lshlrev_b32 v130, 16, v100
  v_mul_f32 v116, v116, v130
  v_mul_f32 v116, v116, v166
  v_and_b32 v117, 0xffff0000, v160
  v_and_b32 v130, 0xffff0000, v100
  v_mul_f32 v117, v117, v130
  v_mul_f32 v117, v117, v166
  v_lshlrev_b32 v118, 16, v161
  v_lshlrev_b32 v130, 16, v101
  v_mul_f32 v118, v118, v130
  v_mul_f32 v118, v118, v166
  v_and_b32 v119, 0xffff0000, v161
  v_and_b32 v130, 0xffff0000, v101
  v_mul_f32 v119, v119, v130
  v_mul_f32 v119, v119, v166
  v_lshlrev_b32 v120, 16, v162
  v_lshlrev_b32 v130, 16, v102
  v_mul_f32 v120, v120, v130
  v_mul_f32 v120, v120, v166
  v_and_b32 v121, 0xffff0000, v162
  v_and_b32 v130, 0xffff0000, v102
  v_mul_f32 v121, v121, v130
  v_mul_f32 v121, v121, v166
  v_lshlrev_b32 v122, 16, v163
  v_lshlrev_b32 v130, 16, v103
  v_mul_f32 v122, v122, v130
  v_mul_f32 v122, v122, v166
  v_and_b32 v123, 0xffff0000, v163
  v_and_b32 v130, 0xffff0000, v103
  v_mul_f32 v123, v123, v130
  v_mul_f32 v123, v123, v166
  v_lshlrev_b32 v124, 16, v164
  v_lshlrev_b32 v130, 16, v104
  v_mul_f32 v124, v124, v130
  v_mul_f32 v124, v124, v166
  v_and_b32 v125, 0xffff0000, v164
  v_and_b32 v130, 0xffff0000, v104
  v_mul_f32 v125, v125, v130
  v_mul_f32 v125, v125, v166
  v_lshlrev_b32 v126, 16, v165
  v_lshlrev_b32 v130, 16, v105
  v_mul_f32 v126, v126, v130
  v_mul_f32 v126, v126, v166
  v_and_b32 v127, 0xffff0000, v165
  v_and_b32 v130, 0xffff0000, v105
  v_mul_f32 v127, v127, v130
  v_mul_f32 v127, v127, v166
  s_lshl_b32 s60, s59, 2
  s_add_u32 s60, s60, 162032
  v_mov_b32 v13, s60
  s_mov_b32 s63, 0
gated_mix__ssm_conv_h3__grouped_kv_mqa__prompt_kernel_redsp:
  ds_read_b32 v14, v13
  s_waitcnt lgkmcnt(0)
  v_readfirstlane_b32 s69, v14
  s_nop 3
  s_cmp_ge_u32 s69, 1
  s_cbranch_scc1 gated_mix__ssm_conv_h3__grouped_kv_mqa__prompt_kernel_redsp_ok
  s_add_u32 s63, s63, 1
  s_cmp_gt_u32 s63, 1000000
  s_cbranch_scc1 gated_mix__ssm_conv_h3__grouped_kv_mqa__prompt_kernel_exit
  s_branch gated_mix__ssm_conv_h3__grouped_kv_mqa__prompt_kernel_redsp
gated_mix__ssm_conv_h3__grouped_kv_mqa__prompt_kernel_redsp_ok:
  s_mul_i32 s60, s59, 5120
  s_add_u32 s60, s60, 133120
  v_add_u32 v13, s60, v11
  ds_read_b128 v[76:79], v13 offset:0
  ds_read_b128 v[80:83], v13 offset:1024
  ds_read_b128 v[84:87], v13 offset:2048
  ds_read_b128 v[88:91], v13 offset:3072
  ds_read_b128 v[92:95], v13 offset:4096
  s_waitcnt lgkmcnt(4)
  v_add_f32 v56, v56, v76
  v_add_f32 v57, v57, v77
  v_add_f32 v58, v58, v78
  v_add_f32 v59, v59, v79
  v_fma_f32 v56, v56, v167, v108
  v_fma_f32 v57, v57, v167, v109
  v_fma_f32 v58, v58, v167, v110
  v_fma_f32 v59, v59, v167, v111
  v_cvt_pk_bf16_f32 v56, v56, v57
  v_cvt_pk_bf16_f32 v57, v58, v59
  buffer_store_dwordx2 v[56:57], v10, s[40:43], s65 offen offset:0
  s_waitcnt lgkmcnt(3)
  v_add_f32 v60, v60, v80
  v_add_f32 v61, v61, v81
  v_add_f32 v62, v62, v82
  v_add_f32 v63, v63, v83
  v_fma_f32 v60, v60, v167, v112
  v_fma_f32 v61, v61, v167, v113
  v_fma_f32 v62, v62, v167, v114
  v_fma_f32 v63, v63, v167, v115
  v_cvt_pk_bf16_f32 v60, v60, v61
  v_cvt_pk_bf16_f32 v61, v62, v63
  buffer_store_dwordx2 v[60:61], v10, s[40:43], s65 offen offset:32
  s_waitcnt lgkmcnt(2)
  v_add_f32 v64, v64, v84
  v_add_f32 v65, v65, v85
  v_add_f32 v66, v66, v86
  v_add_f32 v67, v67, v87
  v_fma_f32 v64, v64, v167, v116
  v_fma_f32 v65, v65, v167, v117
  v_fma_f32 v66, v66, v167, v118
  v_fma_f32 v67, v67, v167, v119
  v_cvt_pk_bf16_f32 v64, v64, v65
  v_cvt_pk_bf16_f32 v65, v66, v67
  buffer_store_dwordx2 v[64:65], v10, s[40:43], s65 offen offset:64
  s_waitcnt lgkmcnt(1)
  v_add_f32 v68, v68, v88
  v_add_f32 v69, v69, v89
  v_add_f32 v70, v70, v90
  v_add_f32 v71, v71, v91
  v_fma_f32 v68, v68, v167, v120
  v_fma_f32 v69, v69, v167, v121
  v_fma_f32 v70, v70, v167, v122
  v_fma_f32 v71, v71, v167, v123
  v_cvt_pk_bf16_f32 v68, v68, v69
  v_cvt_pk_bf16_f32 v69, v70, v71
  buffer_store_dwordx2 v[68:69], v10, s[40:43], s65 offen offset:96
  s_waitcnt lgkmcnt(0)
  v_add_f32 v72, v72, v92
  v_add_f32 v73, v73, v93
  v_add_f32 v74, v74, v94
  v_add_f32 v75, v75, v95
  v_fma_f32 v72, v72, v167, v124
  v_fma_f32 v73, v73, v167, v125
  v_fma_f32 v74, v74, v167, v126
  v_fma_f32 v75, v75, v167, v127
  v_cvt_pk_bf16_f32 v72, v72, v73
  v_cvt_pk_bf16_f32 v73, v74, v75
  buffer_store_dwordx2 v[72:73], v10, s[40:43], s65 offen offset:128
  s_branch gated_mix__ssm_conv_h3__grouped_kv_mqa__prompt_kernel_exit
gated_mix__ssm_conv_h3__grouped_kv_mqa__prompt_kernel_lspin:
  s_mov_b32 s63, 0
gated_mix__ssm_conv_h3__grouped_kv_mqa__prompt_kernel_lspin_r:
  ds_read_b32 v167, v148
  s_waitcnt lgkmcnt(0)
  v_readfirstlane_b32 s69, v167
  s_nop 3
  s_cmp_ge_u32 s69, s71
  s_cbranch_scc1 gated_mix__ssm_conv_h3__grouped_kv_mqa__prompt_kernel_lback
  s_add_u32 s63, s63, 1
  s_cmp_gt_u32 s63, 1000000
  s_cbranch_scc1 gated_mix__ssm_conv_h3__grouped_kv_mqa__prompt_kernel_exit
  s_sleep 1
  s_branch gated_mix__ssm_conv_h3__grouped_kv_mqa__prompt_kernel_lspin_r
gated_mix__ssm_conv_h3__grouped_kv_mqa__prompt_kernel_lspinF:
  s_mov_b32 s63, 0
gated_mix__ssm_conv_h3__grouped_kv_mqa__prompt_kernel_lspinF_r:
  ds_read_b32 v167, v148
  s_waitcnt lgkmcnt(0)
  v_readfirstlane_b32 s69, v167
  s_nop 3
  s_cmp_ge_u32 s69, s71
  s_cbranch_scc1 gated_mix__ssm_conv_h3__grouped_kv_mqa__prompt_kernel_lbackF
  s_add_u32 s63, s63, 1
  s_cmp_gt_u32 s63, 1000000
  s_cbranch_scc1 gated_mix__ssm_conv_h3__grouped_kv_mqa__prompt_kernel_exit
  s_sleep 1
  s_branch gated_mix__ssm_conv_h3__grouped_kv_mqa__prompt_kernel_lspinF_r
gated_mix__ssm_conv_h3__grouped_kv_mqa__prompt_kernel_sspin:
  s_mov_b32 s63, 0
gated_mix__ssm_conv_h3__grouped_kv_mqa__prompt_kernel_sspin_r:
  ds_read_b32 v167, v148
  s_waitcnt lgkmcnt(0)
  v_readfirstlane_b32 s69, v167
  s_nop 3
  s_cmp_ge_u32 s69, s71
  s_cbranch_scc1 gated_mix__ssm_conv_h3__grouped_kv_mqa__prompt_kernel_sback
  s_add_u32 s63, s63, 1
  s_cmp_gt_u32 s63, 1000000
  s_cbranch_scc1 gated_mix__ssm_conv_h3__grouped_kv_mqa__prompt_kernel_exit
  s_sleep 1
  s_branch gated_mix__ssm_conv_h3__grouped_kv_mqa__prompt_kernel_sspin_r
gated_mix__ssm_conv_h3__grouped_kv_mqa__prompt_kernel_slow:
  v_and_b32 v2, 31, v1
  v_lshrrev_b32 v3, 5, v1
  s_lshr_b32 s66, s58, 2
  s_mul_i32 s66, s66, 2640
  s_add_u32 s66, s66, 79872
  v_lshlrev_b32 v142, 4, v1
  v_add_u32 v142, s66, v142
  v_lshlrev_b32 v150, 3, v2
  v_add_u32 v150, 1024, v150
  v_mov_b32 v151, 1280
  v_cmp_eq_u32 vcc, 0, v3
  v_min_u32 v152, 20, v2
  v_subrev_u32 v153, 12, v2
  v_cndmask_b32 v143, v151, v150, vcc
  v_add_u32 v143, s66, v143
  v_cmp_lt_u32 vcc, 27, v2
  v_mul_u32_u24 v151, 336, v3
  s_nop 0
  v_cndmask_b32 v152, v152, v153, vcc
  v_lshl_add_u32 v144, v152, 4, v151
  v_add_u32 v144, s66, v144
  v_add_u32 v144, 1296, v144
  s_mov_b32 s67, 0xa800
  v_add_u32 v145, s67, v142
  v_add_u32 v146, s67, v143
  v_add_u32 v147, s67, v144
  v_mov_b32 v8, v8
  v_mov_b32 v154, 0xff800000
  v_mov_b32 v155, 0xff800000
  v_mov_b32 v148, 161880
  v_mov_b32 v149, 1
  s_mov_b32 s70, 0
  s_mov_b32 s68, 1
  s_mov_b32 s71, 10
gated_mix__ssm_conv_h3__grouped_kv_mqa__prompt_kernel_sloop:
  s_branch gated_mix__ssm_conv_h3__grouped_kv_mqa__prompt_kernel_sspin
gated_mix__ssm_conv_h3__grouped_kv_mqa__prompt_kernel_sback:
  s_mov_b64 exec, 1
  ds_add_u32 v148, v149 offset:4
  s_mov_b64 exec, -1
  ds_read_b128 v[128:131], v142 offset:0
  ds_read_b64 v[132:133], v143 offset:0
  s_waitcnt lgkmcnt(0)
  v_mfma_f32_32x32x16_bf16 v[16:31], v[128:131], v[4:7], 0
  v_mfma_f32_32x32x16_bf16 v[32:47], v[128:131], v[10:13], 0
  v_mfma_f32_32x32x8_bf16 v[16:31], v[132:133], v[8:9], v[16:31]
  v_mfma_f32_32x32x8_bf16 v[32:47], v[132:133], v[14:15], v[32:47]
  s_nop 15
  v_max3_f32 v154, v16, v17, v154
  v_max3_f32 v154, v18, v19, v154
  v_max3_f32 v154, v20, v21, v154
  v_max3_f32 v154, v22, v23, v154
  v_max3_f32 v154, v24, v25, v154
  v_max3_f32 v154, v26, v27, v154
  v_max3_f32 v154, v28, v29, v154
  v_max3_f32 v154, v30, v31, v154
  v_max3_f32 v155, v32, v33, v155
  v_max3_f32 v155, v34, v35, v155
  v_max3_f32 v155, v36, v37, v155
  v_max3_f32 v155, v38, v39, v155
  v_max3_f32 v155, v40, v41, v155
  v_max3_f32 v155, v42, v43, v155
  v_max3_f32 v155, v44, v45, v155
  v_max3_f32 v155, v46, v47, v155
  ds_read_b128 v[128:131], v142 offset:5280
  ds_read_b64 v[132:133], v143 offset:5280
  s_waitcnt lgkmcnt(0)
  v_mfma_f32_32x32x16_bf16 v[16:31], v[128:131], v[4:7], 0
  v_mfma_f32_32x32x16_bf16 v[32:47], v[128:131], v[10:13], 0
  v_mfma_f32_32x32x8_bf16 v[16:31], v[132:133], v[8:9], v[16:31]
  v_mfma_f32_32x32x8_bf16 v[32:47], v[132:133], v[14:15], v[32:47]
  s_nop 15
  v_max3_f32 v154, v16, v17, v154
  v_max3_f32 v154, v18, v19, v154
  v_max3_f32 v154, v20, v21, v154
  v_max3_f32 v154, v22, v23, v154
  v_max3_f32 v154, v24, v25, v154
  v_max3_f32 v154, v26, v27, v154
  v_max3_f32 v154, v28, v29, v154
  v_max3_f32 v154, v30, v31, v154
  v_max3_f32 v155, v32, v33, v155
  v_max3_f32 v155, v34, v35, v155
  v_max3_f32 v155, v36, v37, v155
  v_max3_f32 v155, v38, v39, v155
  v_max3_f32 v155, v40, v41, v155
  v_max3_f32 v155, v42, v43, v155
  v_max3_f32 v155, v44, v45, v155
  v_max3_f32 v155, v46, v47, v155
  ds_read_b128 v[128:131], v142 offset:10560
  ds_read_b64 v[132:133], v143 offset:10560
  s_waitcnt lgkmcnt(0)
  v_mfma_f32_32x32x16_bf16 v[16:31], v[128:131], v[4:7], 0
  v_mfma_f32_32x32x16_bf16 v[32:47], v[128:131], v[10:13], 0
  v_mfma_f32_32x32x8_bf16 v[16:31], v[132:133], v[8:9], v[16:31]
  v_mfma_f32_32x32x8_bf16 v[32:47], v[132:133], v[14:15], v[32:47]
  s_nop 15
  v_max3_f32 v154, v16, v17, v154
  v_max3_f32 v154, v18, v19, v154
  v_max3_f32 v154, v20, v21, v154
  v_max3_f32 v154, v22, v23, v154
  v_max3_f32 v154, v24, v25, v154
  v_max3_f32 v154, v26, v27, v154
  v_max3_f32 v154, v28, v29, v154
  v_max3_f32 v154, v30, v31, v154
  v_max3_f32 v155, v32, v33, v155
  v_max3_f32 v155, v34, v35, v155
  v_max3_f32 v155, v36, v37, v155
  v_max3_f32 v155, v38, v39, v155
  v_max3_f32 v155, v40, v41, v155
  v_max3_f32 v155, v42, v43, v155
  v_max3_f32 v155, v44, v45, v155
  v_max3_f32 v155, v46, v47, v155
  ds_read_b128 v[128:131], v142 offset:15840
  ds_read_b64 v[132:133], v143 offset:15840
  s_waitcnt lgkmcnt(0)
  v_mfma_f32_32x32x16_bf16 v[16:31], v[128:131], v[4:7], 0
  v_mfma_f32_32x32x16_bf16 v[32:47], v[128:131], v[10:13], 0
  v_mfma_f32_32x32x8_bf16 v[16:31], v[132:133], v[8:9], v[16:31]
  v_mfma_f32_32x32x8_bf16 v[32:47], v[132:133], v[14:15], v[32:47]
  s_nop 15
  v_max3_f32 v154, v16, v17, v154
  v_max3_f32 v154, v18, v19, v154
  v_max3_f32 v154, v20, v21, v154
  v_max3_f32 v154, v22, v23, v154
  v_max3_f32 v154, v24, v25, v154
  v_max3_f32 v154, v26, v27, v154
  v_max3_f32 v154, v28, v29, v154
  v_max3_f32 v154, v30, v31, v154
  v_max3_f32 v155, v32, v33, v155
  v_max3_f32 v155, v34, v35, v155
  v_max3_f32 v155, v36, v37, v155
  v_max3_f32 v155, v38, v39, v155
  v_max3_f32 v155, v40, v41, v155
  v_max3_f32 v155, v42, v43, v155
  v_max3_f32 v155, v44, v45, v155
  v_max3_f32 v155, v46, v47, v155
  v_mov_b32 v142, v145
  v_mov_b32 v143, v146
  v_mov_b32 v144, v147
  s_mov_b32 s69, 0xffffac00
  s_cmp_eq_u32 s68, 0
  s_cselect_b32 s69, 0xa800, s69
  s_cmp_eq_u32 s68, 2
  s_cselect_b32 s69, 0xffffac00, s69
  v_add_u32 v145, s69, v145
  v_add_u32 v146, s69, v146
  v_add_u32 v147, s69, v147
  s_add_u32 s68, s68, 1
  s_cmp_eq_u32 s68, 3
  s_cselect_b32 s68, 0, s68
  s_add_u32 s71, s71, 1
  s_min_u32 s71, s71, 16
  s_add_u32 s70, s70, 1
  s_cmp_lt_u32 s70, 8
  s_cbranch_scc1 gated_mix__ssm_conv_h3__grouped_kv_mqa__prompt_kernel_sloop
  s_mov_b64 exec, 1
  ds_add_u32 v148, v149 offset:4
  s_mov_b64 exec, -1
  v_mov_b32 v156, v154
  s_nop 1
  v_permlane32_swap_b32 v154, v156
  v_max_f32 v154, v154, v156
  v_mov_b32 v156, v155
  s_nop 1
  v_permlane32_swap_b32 v155, v156
  v_max_f32 v155, v155, v156
  s_lshl_b32 s60, s58, 9
  s_add_u32 s60, s60, 144384
  v_lshlrev_b32 v150, 3, v1
  v_add_u32 v151, s60, v150
  ds_write_b64 v151, v[154:155]
  s_lshl_b32 s60, s58, 2
  s_add_u32 s60, s60, 161888
  v_mov_b32 v152, s60
  s_waitcnt lgkmcnt(0)
  ds_write_b32 v152, v149
  s_xor_b32 s60, s58, 4
  s_lshl_b32 s61, s60, 2
  s_add_u32 s61, s61, 161888
  v_mov_b32 v152, s61
  s_lshl_b32 s60, s60, 9
  s_add_u32 s60, s60, 144384
  v_add_u32 v151, s60, v150
  s_mov_b32 s63, 0
gated_mix__ssm_conv_h3__grouped_kv_mqa__prompt_kernel_xsp:
  ds_read_b32 v153, v152
  s_waitcnt lgkmcnt(0)
  v_readfirstlane_b32 s69, v153
  s_nop 3
  s_add_u32 s63, s63, 1
  s_cmp_gt_u32 s63, 1000000
  s_cbranch_scc1 gated_mix__ssm_conv_h3__grouped_kv_mqa__prompt_kernel_exit
  s_cmp_eq_u32 s69, 0
  s_cbranch_scc1 gated_mix__ssm_conv_h3__grouped_kv_mqa__prompt_kernel_xsp
  ds_read_b64 v[156:157], v151
  s_waitcnt lgkmcnt(0)
  v_max_f32 v154, v154, v156
  v_max_f32 v155, v155, v157
  v_and_b32 v2, 31, v1
  v_lshrrev_b32 v3, 5, v1
  s_lshr_b32 s66, s58, 2
  s_mul_i32 s66, s66, 2640
  s_add_u32 s66, s66, 79872
  v_lshlrev_b32 v142, 4, v1
  v_add_u32 v142, s66, v142
  v_lshlrev_b32 v150, 3, v2
  v_add_u32 v150, 1024, v150
  v_mov_b32 v151, 1280
  v_cmp_eq_u32 vcc, 0, v3
  v_min_u32 v152, 20, v2
  v_subrev_u32 v153, 12, v2
  v_cndmask_b32 v143, v151, v150, vcc
  v_add_u32 v143, s66, v143
  v_cmp_lt_u32 vcc, 27, v2
  v_mul_u32_u24 v151, 336, v3
  s_nop 0
  v_cndmask_b32 v152, v152, v153, vcc
  v_lshl_add_u32 v144, v152, 4, v151
  v_add_u32 v144, s66, v144
  v_add_u32 v144, 1296, v144
  s_mov_b32 s67, 0xa800
  v_add_u32 v145, s67, v142
  v_add_u32 v146, s67, v143
  v_add_u32 v147, s67, v144
  s_mov_b32 s71, 17
  s_mov_b32 s63, 0
gated_mix__ssm_conv_h3__grouped_kv_mqa__prompt_kernel_x2:
  ds_read_b32 v167, v148
  s_waitcnt lgkmcnt(0)
  v_readfirstlane_b32 s69, v167
  s_nop 3
  s_add_u32 s63, s63, 1
  s_cmp_gt_u32 s63, 1000000
  s_cbranch_scc1 gated_mix__ssm_conv_h3__grouped_kv_mqa__prompt_kernel_exit
  s_cmp_lt_u32 s69, s71
  s_cbranch_scc1 gated_mix__ssm_conv_h3__grouped_kv_mqa__prompt_kernel_x2
  s_mov_b32 s67, 16
  ds_read_b128 v[128:131], v142
  ds_read_b64 v[132:133], v143
  v_mov_b32 v80, 0
  v_mov_b32 v81, 0
  v_mov_b32 v82, 0
  v_mov_b32 v83, 0
  v_mov_b32 v84, 0
  v_mov_b32 v85, 0
  v_mov_b32 v86, 0
  v_mov_b32 v87, 0
  v_mov_b32 v88, 0
  v_mov_b32 v89, 0
  v_mov_b32 v90, 0
  v_mov_b32 v91, 0
  v_mov_b32 v92, 0
  v_mov_b32 v93, 0
  v_mov_b32 v94, 0
  v_mov_b32 v95, 0
  v_mov_b32 v96, 0
  v_mov_b32 v97, 0
  v_mov_b32 v98, 0
  v_mov_b32 v99, 0
  v_mov_b32 v100, 0
  v_mov_b32 v101, 0
  v_mov_b32 v102, 0
  v_mov_b32 v103, 0
  v_mov_b32 v104, 0
  v_mov_b32 v105, 0
  v_mov_b32 v106, 0
  v_mov_b32 v107, 0
  v_mov_b32 v108, 0
  v_mov_b32 v109, 0
  v_mov_b32 v110, 0
  v_mov_b32 v111, 0
  v_cmp_eq_u32 vcc, 0, v3
  s_nop 1
  v_sub_f32 v160, 0, v154
  v_cvt_pk_bf16_f32 v161, v160, v160
  v_and_b32 v162, 0xffff0000, v161
  v_sub_f32 v160, v160, v162
  v_cvt_pk_bf16_f32 v163, v160, v160
  v_and_b32 v162, 0xffff0000, v163
  v_sub_f32 v160, v160, v162
  v_and_b32 v161, 0xffff, v161
  v_or_b32 v161, v161, v162
  v_cvt_pk_bf16_f32 v160, v160, 0
  v_cndmask_b32 v8, v161, v8, vcc
  v_cndmask_b32 v9, v160, v9, vcc
  v_sub_f32 v164, 0, v155
  v_cvt_pk_bf16_f32 v165, v164, v164
  v_and_b32 v166, 0xffff0000, v165
  v_sub_f32 v164, v164, v166
  v_cvt_pk_bf16_f32 v167, v164, v164
  v_and_b32 v166, 0xffff0000, v167
  v_sub_f32 v164, v164, v166
  v_and_b32 v165, 0xffff, v165
  v_or_b32 v165, v165, v166
  v_cvt_pk_bf16_f32 v164, v164, 0
  v_cndmask_b32 v14, v165, v14, vcc
  v_cndmask_b32 v15, v164, v15, vcc
  s_waitcnt lgkmcnt(0)
  v_mfma_f32_32x32x16_bf16 v[16:31], v[128:131], v[4:7], 0
  v_mfma_f32_32x32x16_bf16 v[32:47], v[128:131], v[10:13], 0
  v_mfma_f32_32x32x8_bf16 v[16:31], v[132:133], v[8:9], v[16:31]
  v_mfma_f32_32x32x8_bf16 v[32:47], v[132:133], v[14:15], v[32:47]
  ds_read_b128 v[128:131], v142 offset:5280
  ds_read_b64 v[132:133], v143 offset:5280
  ds_read_b128 v[134:137], v144
  ds_read_b128 v[138:141], v144 offset:672
  s_mov_b32 s70, 0
  s_mov_b32 s68, 1
  s_add_u32 s71, s67, 2
  s_add_u32 s67, s67, 8
  v_mov_b32 v148, 161880
  v_mov_b32 v149, 1
  s_nop 15
.p2align 6
gated_mix__ssm_conv_h3__grouped_kv_mqa__prompt_kernel_loopF:
  s_setprio 2
  s_waitcnt lgkmcnt(2)
  v_mfma_f32_32x32x16_bf16 v[48:63], v[128:131], v[4:7], 0
  v_exp_f32 v16, v16
  v_exp_f32 v17, v17
  v_exp_f32 v18, v18
  v_exp_f32 v19, v19
  v_mfma_f32_32x32x16_bf16 v[64:79], v[128:131], v[10:13], 0
  v_exp_f32 v20, v20
  v_exp_f32 v21, v21
  v_exp_f32 v22, v22
  v_exp_f32 v23, v23
  v_mfma_f32_32x32x8_bf16 v[48:63], v[132:133], v[8:9], v[48:63]
  v_cvt_pk_bf16_f32 v112, v16, v17
  v_cvt_pk_bf16_f32 v113, v18, v19
  v_cvt_pk_bf16_f32 v114, v20, v21
  v_cvt_pk_bf16_f32 v115, v22, v23
  v_exp_f32 v24, v24
  v_exp_f32 v25, v25
  v_mfma_f32_32x32x8_bf16 v[64:79], v[132:133], v[14:15], v[64:79]
  ds_read_b128 v[128:131], v142 offset:10560
  ds_read_b64 v[132:133], v143 offset:10560
  v_exp_f32 v26, v26
  v_exp_f32 v27, v27
  v_exp_f32 v28, v28
  v_exp_f32 v29, v29
  s_waitcnt lgkmcnt(3)
  v_mfma_f32_32x32x16_bf16 v[80:95], v[134:137], v[112:115], v[80:95]
  v_exp_f32 v30, v30
  v_exp_f32 v31, v31
  v_exp_f32 v32, v32
  v_exp_f32 v33, v33
  v_cvt_pk_bf16_f32 v116, v24, v25
  v_cvt_pk_bf16_f32 v117, v26, v27
  v_cvt_pk_bf16_f32 v118, v28, v29
  v_cvt_pk_bf16_f32 v119, v30, v31
  v_exp_f32 v34, v34
  v_exp_f32 v35, v35
  s_waitcnt lgkmcnt(2)
  v_mfma_f32_32x32x16_bf16 v[80:95], v[138:141], v[116:119], v[80:95]
  v_exp_f32 v36, v36
  v_exp_f32 v37, v37
  v_exp_f32 v38, v38
  v_exp_f32 v39, v39
  v_cvt_pk_bf16_f32 v120, v32, v33
  v_cvt_pk_bf16_f32 v121, v34, v35
  v_cvt_pk_bf16_f32 v122, v36, v37
  v_cvt_pk_bf16_f32 v123, v38, v39
  v_exp_f32 v40, v40
  v_exp_f32 v41, v41
  v_mfma_f32_32x32x16_bf16 v[96:111], v[134:137], v[120:123], v[96:111]
  ds_read_b128 v[134:137], v144 offset:5280
  v_exp_f32 v42, v42
  v_exp_f32 v43, v43
  v_exp_f32 v44, v44
  v_exp_f32 v45, v45
  v_exp_f32 v46, v46
  v_exp_f32 v47, v47
  v_cvt_pk_bf16_f32 v124, v40, v41
  v_cvt_pk_bf16_f32 v125, v42, v43
  v_cvt_pk_bf16_f32 v126, v44, v45
  v_cvt_pk_bf16_f32 v127, v46, v47
  s_nop 1
  v_mfma_f32_32x32x16_bf16 v[96:111], v[138:141], v[124:127], v[96:111]
  ds_read_b128 v[138:141], v144 offset:5952
  s_setprio 1
  s_waitcnt lgkmcnt(2)
  v_mfma_f32_32x32x16_bf16 v[16:31], v[128:131], v[4:7], 0
  v_exp_f32 v48, v48
  v_exp_f32 v49, v49
  v_exp_f32 v50, v50
  v_exp_f32 v51, v51
  v_mfma_f32_32x32x16_bf16 v[32:47], v[128:131], v[10:13], 0
  v_exp_f32 v52, v52
  v_exp_f32 v53, v53
  v_exp_f32 v54, v54
  v_exp_f32 v55, v55
  v_mfma_f32_32x32x8_bf16 v[16:31], v[132:133], v[8:9], v[16:31]
  v_cvt_pk_bf16_f32 v112, v48, v49
  v_cvt_pk_bf16_f32 v113, v50, v51
  v_cvt_pk_bf16_f32 v114, v52, v53
  v_cvt_pk_bf16_f32 v115, v54, v55
  v_exp_f32 v56, v56
  v_exp_f32 v57, v57
  v_mfma_f32_32x32x8_bf16 v[32:47], v[132:133], v[14:15], v[32:47]
  ds_read_b128 v[128:131], v142 offset:15840
  ds_read_b64 v[132:133], v143 offset:15840
  ds_read_b32 v167, v148
  v_exp_f32 v58, v58
  v_exp_f32 v59, v59
  v_exp_f32 v60, v60
  v_exp_f32 v61, v61
  s_waitcnt lgkmcnt(4)
  v_mfma_f32_32x32x16_bf16 v[80:95], v[134:137], v[112:115], v[80:95]
  v_exp_f32 v62, v62
  v_exp_f32 v63, v63
  v_exp_f32 v64, v64
  v_exp_f32 v65, v65
  v_cvt_pk_bf16_f32 v116, v56, v57
  v_cvt_pk_bf16_f32 v117, v58, v59
  v_cvt_pk_bf16_f32 v118, v60, v61
  v_cvt_pk_bf16_f32 v119, v62, v63
  v_exp_f32 v66, v66
  v_exp_f32 v67, v67
  s_waitcnt lgkmcnt(3)
  v_mfma_f32_32x32x16_bf16 v[80:95], v[138:141], v[116:119], v[80:95]
  v_exp_f32 v68, v68
  v_exp_f32 v69, v69
  v_exp_f32 v70, v70
  v_exp_f32 v71, v71
  v_cvt_pk_bf16_f32 v120, v64, v65
  v_cvt_pk_bf16_f32 v121, v66, v67
  v_cvt_pk_bf16_f32 v122, v68, v69
  v_cvt_pk_bf16_f32 v123, v70, v71
  v_exp_f32 v72, v72
  v_exp_f32 v73, v73
  v_mfma_f32_32x32x16_bf16 v[96:111], v[134:137], v[120:123], v[96:111]
  ds_read_b128 v[134:137], v144 offset:10560
  v_exp_f32 v74, v74
  v_exp_f32 v75, v75
  v_exp_f32 v76, v76
  v_exp_f32 v77, v77
  v_exp_f32 v78, v78
  v_exp_f32 v79, v79
  v_cvt_pk_bf16_f32 v124, v72, v73
  v_cvt_pk_bf16_f32 v125, v74, v75
  v_cvt_pk_bf16_f32 v126, v76, v77
  v_cvt_pk_bf16_f32 v127, v78, v79
  s_nop 1
  v_mfma_f32_32x32x16_bf16 v[96:111], v[138:141], v[124:127], v[96:111]
  ds_read_b128 v[138:141], v144 offset:11232
  s_setprio 3
  s_waitcnt lgkmcnt(2)
  v_readfirstlane_b32 s69, v167
  s_nop 3
  s_cmp_ge_u32 s69, s71
  s_cbranch_scc0 gated_mix__ssm_conv_h3__grouped_kv_mqa__prompt_kernel_lspinF
gated_mix__ssm_conv_h3__grouped_kv_mqa__prompt_kernel_lbackF:
  v_mfma_f32_32x32x16_bf16 v[48:63], v[128:131], v[4:7], 0
  v_exp_f32 v16, v16
  v_exp_f32 v17, v17
  v_exp_f32 v18, v18
  v_exp_f32 v19, v19
  v_mfma_f32_32x32x16_bf16 v[64:79], v[128:131], v[10:13], 0
  v_exp_f32 v20, v20
  v_exp_f32 v21, v21
  v_exp_f32 v22, v22
  v_exp_f32 v23, v23
  v_mfma_f32_32x32x8_bf16 v[48:63], v[132:133], v[8:9], v[48:63]
  v_cvt_pk_bf16_f32 v112, v16, v17
  v_cvt_pk_bf16_f32 v113, v18, v19
  v_cvt_pk_bf16_f32 v114, v20, v21
  v_cvt_pk_bf16_f32 v115, v22, v23
  v_exp_f32 v24, v24
  v_exp_f32 v25, v25
  v_mfma_f32_32x32x8_bf16 v[64:79], v[132:133], v[14:15], v[64:79]
  ds_read_b128 v[128:131], v145 offset:0
  ds_read_b64 v[132:133], v146 offset:0
  s_mov_b64 exec, 1
  ds_add_u32 v148, v149 offset:4
  s_mov_b64 exec, -1
  v_exp_f32 v26, v26
  v_exp_f32 v27, v27
  v_exp_f32 v28, v28
  v_exp_f32 v29, v29
  s_waitcnt lgkmcnt(4)
  v_mfma_f32_32x32x16_bf16 v[80:95], v[134:137], v[112:115], v[80:95]
  v_exp_f32 v30, v30
  v_exp_f32 v31, v31
  v_exp_f32 v32, v32
  v_exp_f32 v33, v33
  v_cvt_pk_bf16_f32 v116, v24, v25
  v_cvt_pk_bf16_f32 v117, v26, v27
  v_cvt_pk_bf16_f32 v118, v28, v29
  v_cvt_pk_bf16_f32 v119, v30, v31
  v_exp_f32 v34, v34
  v_exp_f32 v35, v35
  s_waitcnt lgkmcnt(3)
  v_mfma_f32_32x32x16_bf16 v[80:95], v[138:141], v[116:119], v[80:95]
  v_exp_f32 v36, v36
  v_exp_f32 v37, v37
  v_exp_f32 v38, v38
  v_exp_f32 v39, v39
  v_cvt_pk_bf16_f32 v120, v32, v33
  v_cvt_pk_bf16_f32 v121, v34, v35
  v_cvt_pk_bf16_f32 v122, v36, v37
  v_cvt_pk_bf16_f32 v123, v38, v39
  v_exp_f32 v40, v40
  v_exp_f32 v41, v41
  v_mfma_f32_32x32x16_bf16 v[96:111], v[134:137], v[120:123], v[96:111]
  ds_read_b128 v[134:137], v144 offset:15840
  v_exp_f32 v42, v42
  v_exp_f32 v43, v43
  v_exp_f32 v44, v44
  v_exp_f32 v45, v45
  v_exp_f32 v46, v46
  v_exp_f32 v47, v47
  v_cvt_pk_bf16_f32 v124, v40, v41
  v_cvt_pk_bf16_f32 v125, v42, v43
  v_cvt_pk_bf16_f32 v126, v44, v45
  v_cvt_pk_bf16_f32 v127, v46, v47
  s_nop 1
  v_mfma_f32_32x32x16_bf16 v[96:111], v[138:141], v[124:127], v[96:111]
  ds_read_b128 v[138:141], v144 offset:16512
  s_setprio 2
  s_waitcnt lgkmcnt(2)
  v_mfma_f32_32x32x16_bf16 v[16:31], v[128:131], v[4:7], 0
  v_exp_f32 v48, v48
  v_exp_f32 v49, v49
  v_exp_f32 v50, v50
  v_exp_f32 v51, v51
  v_mfma_f32_32x32x16_bf16 v[32:47], v[128:131], v[10:13], 0
  v_exp_f32 v52, v52
  v_exp_f32 v53, v53
  v_exp_f32 v54, v54
  v_exp_f32 v55, v55
  v_mfma_f32_32x32x8_bf16 v[16:31], v[132:133], v[8:9], v[16:31]
  v_cvt_pk_bf16_f32 v112, v48, v49
  v_cvt_pk_bf16_f32 v113, v50, v51
  v_cvt_pk_bf16_f32 v114, v52, v53
  v_cvt_pk_bf16_f32 v115, v54, v55
  v_exp_f32 v56, v56
  v_exp_f32 v57, v57
  v_mfma_f32_32x32x8_bf16 v[32:47], v[132:133], v[14:15], v[32:47]
  ds_read_b128 v[128:131], v145 offset:5280
  ds_read_b64 v[132:133], v146 offset:5280
  v_exp_f32 v58, v58
  v_exp_f32 v59, v59
  v_exp_f32 v60, v60
  v_exp_f32 v61, v61
  s_waitcnt lgkmcnt(3)
  v_mfma_f32_32x32x16_bf16 v[80:95], v[134:137], v[112:115], v[80:95]
  v_exp_f32 v62, v62
  v_exp_f32 v63, v63
  v_exp_f32 v64, v64
  v_exp_f32 v65, v65
  v_cvt_pk_bf16_f32 v116, v56, v57
  v_cvt_pk_bf16_f32 v117, v58, v59
  v_cvt_pk_bf16_f32 v118, v60, v61
  v_cvt_pk_bf16_f32 v119, v62, v63
  v_exp_f32 v66, v66
  v_exp_f32 v67, v67
  s_waitcnt lgkmcnt(2)
  v_mfma_f32_32x32x16_bf16 v[80:95], v[138:141], v[116:119], v[80:95]
  v_exp_f32 v68, v68
  v_exp_f32 v69, v69
  v_exp_f32 v70, v70
  v_exp_f32 v71, v71
  v_cvt_pk_bf16_f32 v120, v64, v65
  v_cvt_pk_bf16_f32 v121, v66, v67
  v_cvt_pk_bf16_f32 v122, v68, v69
  v_cvt_pk_bf16_f32 v123, v70, v71
  v_exp_f32 v72, v72
  v_exp_f32 v73, v73
  v_mfma_f32_32x32x16_bf16 v[96:111], v[134:137], v[120:123], v[96:111]
  ds_read_b128 v[134:137], v147 offset:0
  v_exp_f32 v74, v74
  v_exp_f32 v75, v75
  v_exp_f32 v76, v76
  v_exp_f32 v77, v77
  v_exp_f32 v78, v78
  v_exp_f32 v79, v79
  v_cvt_pk_bf16_f32 v124, v72, v73
  v_cvt_pk_bf16_f32 v125, v74, v75
  v_cvt_pk_bf16_f32 v126, v76, v77
  v_cvt_pk_bf16_f32 v127, v78, v79
  s_nop 1
  v_mfma_f32_32x32x16_bf16 v[96:111], v[138:141], v[124:127], v[96:111]
  ds_read_b128 v[138:141], v147 offset:672
  v_mov_b32 v142, v145
  v_mov_b32 v143, v146
  v_mov_b32 v144, v147
  s_mov_b32 s69, 0xffffac00
  s_cmp_eq_u32 s68, 0
  s_cselect_b32 s69, 0xa800, s69
  s_cmp_eq_u32 s68, 2
  s_cselect_b32 s69, 0xffffac00, s69
  v_add_u32 v145, s69, v145
  v_add_u32 v146, s69, v146
  v_add_u32 v147, s69, v147
  s_add_u32 s68, s68, 1
  s_cmp_eq_u32 s68, 3
  s_cselect_b32 s68, 0, s68
  s_add_u32 s71, s71, 1
  s_min_u32 s71, s71, s67
  s_add_u32 s70, s70, 1
  s_cmp_lt_u32 s70, 8
  s_cbranch_scc1 gated_mix__ssm_conv_h3__grouped_kv_mqa__prompt_kernel_loopF
  s_setprio 0
  s_mov_b64 exec, 1
  ds_add_u32 v148, v149 offset:4
  s_mov_b64 exec, -1
  s_nop 15
  s_nop 7
  s_waitcnt lgkmcnt(0)
  s_branch gated_mix__ssm_conv_h3__grouped_kv_mqa__prompt_kernel_passok
gated_mix__ssm_conv_h3__grouped_kv_mqa__prompt_kernel_aux:
  s_setprio 3
  s_waitcnt lgkmcnt(0)
  s_load_dword s98, s[16:17], 0
  s_cmp_lt_u32 s57, 4
  s_cselect_b32 s12, s80, s82
  s_cselect_b32 s13, s81, s83
  v_lshlrev_b32 v13, 4, v1
  s_cmp_lg_u32 s58, 8
  s_cbranch_scc1 gated_mix__ssm_conv_h3__grouped_kv_mqa__prompt_kernel_nok24_0
  s_mov_b32 s61, 24576
  s_mov_b32 m0, 155648
  s_nop 0
  buffer_load_dwordx4 v13, s[12:15], s61 offen lds
gated_mix__ssm_conv_h3__grouped_kv_mqa__prompt_kernel_nok24_0:
  s_sub_u32 s60, s58, 8
  s_lshl_b32 s60, s60, 10
  s_add_u32 s61, s60, 0
  s_add_u32 m0, s61, 131072
  s_nop 0
  buffer_load_dwordx4 v13, s[12:15], s61 offen lds
  s_add_u32 s61, s60, 4096
  s_add_u32 m0, s61, 131072
  s_nop 0
  buffer_load_dwordx4 v13, s[12:15], s61 offen lds
  s_add_u32 s61, s60, 8192
  s_add_u32 m0, s61, 131072
  s_nop 0
  buffer_load_dwordx4 v13, s[12:15], s61 offen lds
  s_add_u32 s61, s60, 12288
  s_add_u32 m0, s61, 131072
  s_nop 0
  buffer_load_dwordx4 v13, s[12:15], s61 offen lds
  s_add_u32 s61, s60, 16384
  s_add_u32 m0, s61, 131072
  s_nop 0
  buffer_load_dwordx4 v13, s[12:15], s61 offen lds
  s_add_u32 s61, s60, 20480
  s_add_u32 m0, s61, 131072
  s_nop 0
  buffer_load_dwordx4 v13, s[12:15], s61 offen lds
  v_subrev_u32 v2, 512, v0
  v_cmp_gt_u32 vcc, 160, v2
  s_nop 3
  s_and_saveexec_b64 s[70:71], vcc
  s_mov_b64 s[72:73], exec
  v_lshlrev_b32 v15, 3, v2
  buffer_load_dwordx2 v[160:161], v15, s[32:35], 0 offen
  v_lshlrev_b32 v162, 5, v2
  v_add_u32 v162, 156736, v162
  s_mov_b64 exec, s[70:71]
  s_sub_u32 s66, s58, 8
  s_mul_i32 s60, s56, 3
  s_lshl_b32 s61, s56, 1
  s_add_u32 s61, s61, 16
  s_cmp_lt_u32 s56, 16
  s_cselect_b32 s60, s60, s61
  s_cselect_b32 s68, 3, 2
  s_add_u32 s60, s60, s66
  s_mul_i32 s61, s57, 80
  s_add_u32 s67, s60, s61
  s_cmp_lt_u32 s66, s68
  s_cselect_b32 s69, 1, 0
  s_mov_b32 s74, s69
  s_mul_i32 s60, s57, 160
  v_add_u32 v13, 0, v1
  v_mul_u32_u24 v14, 0xAAAB, v13
  v_lshrrev_b32 v14, 19, v14
  v_mul_u32_u24 v15, 12, v14
  v_sub_u32 v15, v13, v15
  v_lshrrev_b32 v13, 3, v14
  v_lshlrev_b32 v13, 1, v13
  v_sub_u32 v15, v15, v13
  v_lshlrev_b32 v15, 4, v15
  v_mul_u32_u24 v14, 1280, v14
  v_add_u32 v14, v14, v15
  v_add_u32 v5, s60, v14
  v_add_u32 v13, 64, v1
  v_mul_u32_u24 v14, 0xAAAB, v13
  v_lshrrev_b32 v14, 19, v14
  v_mul_u32_u24 v15, 12, v14
  v_sub_u32 v15, v13, v15
  v_lshrrev_b32 v13, 3, v14
  v_lshlrev_b32 v13, 1, v13
  v_sub_u32 v15, v15, v13
  v_lshlrev_b32 v15, 4, v15
  v_mul_u32_u24 v14, 1280, v14
  v_add_u32 v14, v14, v15
  v_add_u32 v6, s60, v14
  v_add_u32 v13, 128, v1
  v_mul_u32_u24 v14, 0xAAAB, v13
  v_lshrrev_b32 v14, 19, v14
  v_mul_u32_u24 v15, 12, v14
  v_sub_u32 v15, v13, v15
  v_lshrrev_b32 v13, 3, v14
  v_lshlrev_b32 v13, 1, v13
  v_sub_u32 v15, v15, v13
  v_lshlrev_b32 v15, 4, v15
  v_mul_u32_u24 v14, 1280, v14
  v_add_u32 v14, v14, v15
  v_add_u32 v7, s60, v14
  s_barrier
  s_mov_b64 exec, s[72:73]
  s_waitcnt vmcnt(0)
  ds_write_b16 v162, v160
  ds_write_b16_d16_hi v162, v160 offset:8
  ds_write_b16 v162, v161 offset:16
  ds_write_b16_d16_hi v162, v161 offset:24
  s_mov_b64 exec, s[70:71]
  s_waitcnt lgkmcnt(0)
  s_add_u32 s98, s98, 1
  v_mov_b32 v13, 162048
  v_mov_b32 v14, 1
  s_mov_b64 exec, 1
  ds_add_u32 v13, v14
  s_mov_b64 exec, -1
  s_cmp_lg_u32 s58, 9
  s_cbranch_scc1 gated_mix__ssm_conv_h3__grouped_kv_mqa__prompt_kernel_auxgo
  v_and_b32 v2, 15, v1
  v_bfe_u32 v3, v1, 4, 2
  s_and_b32 s59, s57, 3
  v_lshrrev_b32 v13, 3, v2
  s_lshl_b32 s60, s59, 1
  v_add_u32 v13, s60, v13
  v_mul_u32_u24 v13, 10240, v13
  v_and_b32 v14, 7, v2
  v_lshl_add_u32 v13, v14, 7, v13
  v_bfe_u32 v14, v2, 1, 3
  v_xor_b32 v15, v3, v14
  v_lshl_add_u32 v56, v15, 4, v13
  v_add_u32 v15, 4, v3
  v_xor_b32 v15, v15, v14
  v_lshl_add_u32 v57, v15, 4, v13
  s_lshl_b32 s64, s59, 2
  s_add_u32 s64, s64, 161984
  v_mov_b32 v10, s64
  s_mov_b32 s63, 0
gated_mix__ssm_conv_h3__grouped_kv_mqa__prompt_kernel_axsp:
  ds_read_b32 v11, v10
  s_waitcnt lgkmcnt(0)
  v_readfirstlane_b32 s69, v11
  s_nop 3
  s_cmp_ge_u32 s69, 2
  s_cbranch_scc1 gated_mix__ssm_conv_h3__grouped_kv_mqa__prompt_kernel_axsp_ok
  s_add_u32 s63, s63, 1
  s_cmp_gt_u32 s63, 1000000
  s_cbranch_scc1 gated_mix__ssm_conv_h3__grouped_kv_mqa__prompt_kernel_exit
  s_branch gated_mix__ssm_conv_h3__grouped_kv_mqa__prompt_kernel_axsp
gated_mix__ssm_conv_h3__grouped_kv_mqa__prompt_kernel_axsp_ok:
  ds_read_b128 v[104:107], v56 offset:5120
  ds_read_b128 v[108:111], v57 offset:5120
  ds_read_b128 v[112:115], v56 offset:6144
  ds_read_b128 v[116:119], v57 offset:6144
  ds_read_b128 v[120:123], v56 offset:7168
  ds_read_b128 v[124:127], v57 offset:7168
  ds_read_b128 v[128:131], v56 offset:8192
  ds_read_b128 v[132:135], v57 offset:8192
  ds_read_b128 v[136:139], v56 offset:9216
  ds_read_b128 v[140:143], v57 offset:9216
  s_waitcnt lgkmcnt(0)
  s_add_u32 s64, s64, 16
  v_mov_b32 v10, s64
  v_mov_b32 v11, 1
  s_mov_b64 exec, 1
  ds_add_u32 v10, v11
  s_mov_b64 exec, -1
  v_mov_b32 v10, 162048
  s_mov_b32 s63, 0
gated_mix__ssm_conv_h3__grouped_kv_mqa__prompt_kernel_akvin:
  ds_read_b32 v11, v10
  s_waitcnt lgkmcnt(0)
  v_readfirstlane_b32 s69, v11
  s_nop 3
  s_cmp_ge_u32 s69, 4
  s_cbranch_scc1 gated_mix__ssm_conv_h3__grouped_kv_mqa__prompt_kernel_akvin_ok
  s_add_u32 s63, s63, 1
  s_cmp_gt_u32 s63, 1000000
  s_cbranch_scc1 gated_mix__ssm_conv_h3__grouped_kv_mqa__prompt_kernel_exit
  s_branch gated_mix__ssm_conv_h3__grouped_kv_mqa__prompt_kernel_akvin
gated_mix__ssm_conv_h3__grouped_kv_mqa__prompt_kernel_akvin_ok:
  v_lshrrev_b32 v13, 2, v2
  v_lshl_add_u32 v13, v3, 3, v13
  v_mul_u32_u24 v58, 40, v13
  v_and_b32 v15, 3, v1
  v_lshl_add_u32 v10, v15, 3, v58
  v_add_u32 v10, 131072, v10
  v_add_u32 v11, 143904, v58
  v_lshlrev_b32 v13, 3, v13
  v_add_u32 v13, 159296, v13
  v_cmp_eq_u32 vcc, 0, v15
  v_mov_b32 v12, 256
  v_mov_b32 v58, 1280
  v_cndmask_b32 v11, v13, v11, vcc
  v_cndmask_b32 v12, v12, v58, vcc
  v_mov_b32 v13, 32
  v_mov_b32 v58, 160
  v_cndmask_b32 v13, v13, v58, vcc
  v_add_u32 v14, v11, v13
  v_mov_b32 v152, 0
  v_mov_b32 v153, 0
  v_mov_b32 v154, 0
  v_mov_b32 v155, 0
  v_mov_b32 v156, 0
  v_mov_b32 v157, 0
  v_mov_b32 v158, 0
  v_mov_b32 v159, 0
  s_cmp_ge_u32 s57, 4
  s_cbranch_scc1 gated_mix__ssm_conv_h3__grouped_kv_mqa__prompt_kernel_kvVA
  ds_read_b64_tr_b16 v[16:17], v10 offset:12800
  ds_read_b64_tr_b16 v[18:19], v10 offset:12960
  ds_read_b64_tr_b16 v[20:21], v11
  ds_read_b64_tr_b16 v[22:23], v14
  v_add_u32 v11, v11, v12
  v_add_u32 v14, v14, v12
  ds_read_b64_tr_b16 v[24:25], v10 offset:14080
  ds_read_b64_tr_b16 v[26:27], v10 offset:14240
  ds_read_b64_tr_b16 v[28:29], v11
  ds_read_b64_tr_b16 v[30:31], v14
  v_add_u32 v11, v11, v12
  v_add_u32 v14, v14, v12
  ds_read_b64_tr_b16 v[32:33], v10 offset:15360
  ds_read_b64_tr_b16 v[34:35], v10 offset:15520
  ds_read_b64_tr_b16 v[36:37], v11
  ds_read_b64_tr_b16 v[38:39], v14
  v_add_u32 v11, v11, v12
  v_add_u32 v14, v14, v12
  ds_read_b64_tr_b16 v[40:41], v10 offset:16640
  ds_read_b64_tr_b16 v[42:43], v10 offset:16800
  ds_read_b64_tr_b16 v[44:45], v11
  ds_read_b64_tr_b16 v[46:47], v14
  v_add_u32 v11, v11, v12
  v_add_u32 v14, v14, v12
  s_waitcnt lgkmcnt(12)
  v_mfma_f32_16x16x32_bf16 v[152:155], v[16:19], v[104:107], v[152:155]
  v_mfma_f32_16x16x32_bf16 v[156:159], v[20:23], v[104:107], v[156:159]
  ds_read_b64_tr_b16 v[48:49], v10 offset:17920
  ds_read_b64_tr_b16 v[50:51], v10 offset:18080
  ds_read_b64_tr_b16 v[52:53], v11
  ds_read_b64_tr_b16 v[54:55], v14
  v_add_u32 v11, v11, v12
  v_add_u32 v14, v14, v12
  s_waitcnt lgkmcnt(12)
  v_mfma_f32_16x16x32_bf16 v[152:155], v[24:27], v[108:111], v[152:155]
  v_mfma_f32_16x16x32_bf16 v[156:159], v[28:31], v[108:111], v[156:159]
  ds_read_b64_tr_b16 v[64:65], v10 offset:19200
  ds_read_b64_tr_b16 v[66:67], v10 offset:19360
  ds_read_b64_tr_b16 v[68:69], v11
  ds_read_b64_tr_b16 v[70:71], v14
  v_add_u32 v11, v11, v12
  v_add_u32 v14, v14, v12
  s_waitcnt lgkmcnt(12)
  v_mfma_f32_16x16x32_bf16 v[152:155], v[32:35], v[112:115], v[152:155]
  v_mfma_f32_16x16x32_bf16 v[156:159], v[36:39], v[112:115], v[156:159]
  ds_read_b64_tr_b16 v[72:73], v10 offset:20480
  ds_read_b64_tr_b16 v[74:75], v10 offset:20640
  ds_read_b64_tr_b16 v[76:77], v11
  ds_read_b64_tr_b16 v[78:79], v14
  v_add_u32 v11, v11, v12
  v_add_u32 v14, v14, v12
  s_waitcnt lgkmcnt(12)
  v_mfma_f32_16x16x32_bf16 v[152:155], v[40:43], v[116:119], v[152:155]
  v_mfma_f32_16x16x32_bf16 v[156:159], v[44:47], v[116:119], v[156:159]
  ds_read_b64_tr_b16 v[80:81], v10 offset:21760
  ds_read_b64_tr_b16 v[82:83], v10 offset:21920
  ds_read_b64_tr_b16 v[84:85], v11
  ds_read_b64_tr_b16 v[86:87], v14
  v_add_u32 v11, v11, v12
  v_add_u32 v14, v14, v12
  s_waitcnt lgkmcnt(12)
  v_mfma_f32_16x16x32_bf16 v[152:155], v[48:51], v[120:123], v[152:155]
  v_mfma_f32_16x16x32_bf16 v[156:159], v[52:55], v[120:123], v[156:159]
  ds_read_b64_tr_b16 v[88:89], v10 offset:23040
  ds_read_b64_tr_b16 v[90:91], v10 offset:23200
  ds_read_b64_tr_b16 v[92:93], v11
  ds_read_b64_tr_b16 v[94:95], v14
  v_add_u32 v11, v11, v12
  v_add_u32 v14, v14, v12
  s_waitcnt lgkmcnt(12)
  v_mfma_f32_16x16x32_bf16 v[152:155], v[64:67], v[124:127], v[152:155]
  v_mfma_f32_16x16x32_bf16 v[156:159], v[68:71], v[124:127], v[156:159]
  ds_read_b64_tr_b16 v[96:97], v10 offset:24320
  ds_read_b64_tr_b16 v[98:99], v10 offset:24480
  ds_read_b64_tr_b16 v[100:101], v11
  ds_read_b64_tr_b16 v[102:103], v14
  v_add_u32 v11, v11, v12
  v_add_u32 v14, v14, v12
  s_waitcnt lgkmcnt(12)
  v_mfma_f32_16x16x32_bf16 v[152:155], v[72:75], v[128:131], v[152:155]
  v_mfma_f32_16x16x32_bf16 v[156:159], v[76:79], v[128:131], v[156:159]
  s_waitcnt lgkmcnt(8)
  v_mfma_f32_16x16x32_bf16 v[152:155], v[80:83], v[132:135], v[152:155]
  v_mfma_f32_16x16x32_bf16 v[156:159], v[84:87], v[132:135], v[156:159]
  s_waitcnt lgkmcnt(4)
  v_mfma_f32_16x16x32_bf16 v[152:155], v[88:91], v[136:139], v[152:155]
  v_mfma_f32_16x16x32_bf16 v[156:159], v[92:95], v[136:139], v[156:159]
  s_waitcnt lgkmcnt(0)
  v_mfma_f32_16x16x32_bf16 v[152:155], v[96:99], v[140:143], v[152:155]
  v_mfma_f32_16x16x32_bf16 v[156:159], v[100:103], v[140:143], v[156:159]
  s_branch gated_mix__ssm_conv_h3__grouped_kv_mqa__prompt_kernel_kvEA
gated_mix__ssm_conv_h3__grouped_kv_mqa__prompt_kernel_kvVA:
  ds_read_b64_tr_b16 v[16:17], v10 offset:12800
  ds_read_b64_tr_b16 v[18:19], v10 offset:12960
  ds_read_b64_tr_b16 v[20:21], v11
  ds_read_b64_tr_b16 v[22:23], v14
  v_add_u32 v11, v11, v12
  v_add_u32 v14, v14, v12
  ds_read_b64_tr_b16 v[24:25], v10 offset:14080
  ds_read_b64_tr_b16 v[26:27], v10 offset:14240
  ds_read_b64_tr_b16 v[28:29], v11
  ds_read_b64_tr_b16 v[30:31], v14
  v_add_u32 v11, v11, v12
  v_add_u32 v14, v14, v12
  ds_read_b64_tr_b16 v[32:33], v10 offset:15360
  ds_read_b64_tr_b16 v[34:35], v10 offset:15520
  ds_read_b64_tr_b16 v[36:37], v11
  ds_read_b64_tr_b16 v[38:39], v14
  v_add_u32 v11, v11, v12
  v_add_u32 v14, v14, v12
  ds_read_b64_tr_b16 v[40:41], v10 offset:16640
  ds_read_b64_tr_b16 v[42:43], v10 offset:16800
  ds_read_b64_tr_b16 v[44:45], v11
  ds_read_b64_tr_b16 v[46:47], v14
  v_add_u32 v11, v11, v12
  v_add_u32 v14, v14, v12
  s_waitcnt lgkmcnt(12)
  v_mfma_f32_16x16x32_bf16 v[152:155], v[104:107], v[16:19], v[152:155]
  v_mfma_f32_16x16x32_bf16 v[156:159], v[104:107], v[20:23], v[156:159]
  ds_read_b64_tr_b16 v[48:49], v10 offset:17920
  ds_read_b64_tr_b16 v[50:51], v10 offset:18080
  ds_read_b64_tr_b16 v[52:53], v11
  ds_read_b64_tr_b16 v[54:55], v14
  v_add_u32 v11, v11, v12
  v_add_u32 v14, v14, v12
  s_waitcnt lgkmcnt(12)
  v_mfma_f32_16x16x32_bf16 v[152:155], v[108:111], v[24:27], v[152:155]
  v_mfma_f32_16x16x32_bf16 v[156:159], v[108:111], v[28:31], v[156:159]
  ds_read_b64_tr_b16 v[64:65], v10 offset:19200
  ds_read_b64_tr_b16 v[66:67], v10 offset:19360
  ds_read_b64_tr_b16 v[68:69], v11
  ds_read_b64_tr_b16 v[70:71], v14
  v_add_u32 v11, v11, v12
  v_add_u32 v14, v14, v12
  s_waitcnt lgkmcnt(12)
  v_mfma_f32_16x16x32_bf16 v[152:155], v[112:115], v[32:35], v[152:155]
  v_mfma_f32_16x16x32_bf16 v[156:159], v[112:115], v[36:39], v[156:159]
  ds_read_b64_tr_b16 v[72:73], v10 offset:20480
  ds_read_b64_tr_b16 v[74:75], v10 offset:20640
  ds_read_b64_tr_b16 v[76:77], v11
  ds_read_b64_tr_b16 v[78:79], v14
  v_add_u32 v11, v11, v12
  v_add_u32 v14, v14, v12
  s_waitcnt lgkmcnt(12)
  v_mfma_f32_16x16x32_bf16 v[152:155], v[116:119], v[40:43], v[152:155]
  v_mfma_f32_16x16x32_bf16 v[156:159], v[116:119], v[44:47], v[156:159]
  ds_read_b64_tr_b16 v[80:81], v10 offset:21760
  ds_read_b64_tr_b16 v[82:83], v10 offset:21920
  ds_read_b64_tr_b16 v[84:85], v11
  ds_read_b64_tr_b16 v[86:87], v14
  v_add_u32 v11, v11, v12
  v_add_u32 v14, v14, v12
  s_waitcnt lgkmcnt(12)
  v_mfma_f32_16x16x32_bf16 v[152:155], v[120:123], v[48:51], v[152:155]
  v_mfma_f32_16x16x32_bf16 v[156:159], v[120:123], v[52:55], v[156:159]
  ds_read_b64_tr_b16 v[88:89], v10 offset:23040
  ds_read_b64_tr_b16 v[90:91], v10 offset:23200
  ds_read_b64_tr_b16 v[92:93], v11
  ds_read_b64_tr_b16 v[94:95], v14
  v_add_u32 v11, v11, v12
  v_add_u32 v14, v14, v12
  s_waitcnt lgkmcnt(12)
  v_mfma_f32_16x16x32_bf16 v[152:155], v[124:127], v[64:67], v[152:155]
  v_mfma_f32_16x16x32_bf16 v[156:159], v[124:127], v[68:71], v[156:159]
  ds_read_b64_tr_b16 v[96:97], v10 offset:24320
  ds_read_b64_tr_b16 v[98:99], v10 offset:24480
  ds_read_b64_tr_b16 v[100:101], v11
  ds_read_b64_tr_b16 v[102:103], v14
  v_add_u32 v11, v11, v12
  v_add_u32 v14, v14, v12
  s_waitcnt lgkmcnt(12)
  v_mfma_f32_16x16x32_bf16 v[152:155], v[128:131], v[72:75], v[152:155]
  v_mfma_f32_16x16x32_bf16 v[156:159], v[128:131], v[76:79], v[156:159]
  s_waitcnt lgkmcnt(8)
  v_mfma_f32_16x16x32_bf16 v[152:155], v[132:135], v[80:83], v[152:155]
  v_mfma_f32_16x16x32_bf16 v[156:159], v[132:135], v[84:87], v[156:159]
  s_waitcnt lgkmcnt(4)
  v_mfma_f32_16x16x32_bf16 v[152:155], v[136:139], v[88:91], v[152:155]
  v_mfma_f32_16x16x32_bf16 v[156:159], v[136:139], v[92:95], v[156:159]
  s_waitcnt lgkmcnt(0)
  v_mfma_f32_16x16x32_bf16 v[152:155], v[140:143], v[96:99], v[152:155]
  v_mfma_f32_16x16x32_bf16 v[156:159], v[140:143], v[100:103], v[156:159]
gated_mix__ssm_conv_h3__grouped_kv_mqa__prompt_kernel_kvEA:
  v_lshlrev_b32 v59, 4, v1
  v_add_u32 v59, 162112, v59
  v_lshl_add_u32 v58, v3, 2, v2
  v_lshlrev_b32 v58, 4, v58
  v_add_u32 v58, 163136, v58
  v_add_u32 v60, 1024, v59
  v_cmp_gt_u32 s[62:63], 4, v2
  s_cmp_lt_u32 s57, 4
  s_nop 2
  s_cselect_b32 s62, -1, s62
  s_cselect_b32 s63, 0, s63
  s_cselect_b64 vcc, -1, 0
  v_cndmask_b32 v58, v58, v60, vcc
  s_nop 7
  ds_write_b128 v59, v[152:155]
  s_mov_b64 exec, s[62:63]
  ds_write_b128 v58, v[156:159]
  s_mov_b64 exec, -1
  s_waitcnt lgkmcnt(0)
  v_mov_b32 v10, 162072
  v_mov_b32 v11, 1
  s_mov_b64 exec, 1
  ds_add_u32 v10, v11
  s_mov_b64 exec, -1
gated_mix__ssm_conv_h3__grouped_kv_mqa__prompt_kernel_auxgo:
  s_setprio 0
  v_subrev_u32 v2, 512, v0
  v_and_b32 v17, 7, v2
  v_lshrrev_b32 v18, 3, v2
  s_mov_b32 s78, 1280
  v_mov_b32 v13, 162064
  s_mov_b32 s63, 0
gated_mix__ssm_conv_h3__grouped_kv_mqa__prompt_kernel_akvd:
  ds_read_b32 v14, v13
  s_waitcnt lgkmcnt(0)
  v_readfirstlane_b32 s69, v14
  s_nop 3
  s_cmp_ge_u32 s69, 1
  s_cbranch_scc1 gated_mix__ssm_conv_h3__grouped_kv_mqa__prompt_kernel_akvd_ok
  s_add_u32 s63, s63, 1
  s_cmp_gt_u32 s63, 1000000
  s_cbranch_scc1 gated_mix__ssm_conv_h3__grouped_kv_mqa__prompt_kernel_exit
  s_branch gated_mix__ssm_conv_h3__grouped_kv_mqa__prompt_kernel_akvd
gated_mix__ssm_conv_h3__grouped_kv_mqa__prompt_kernel_akvd_ok:
  s_mul_i32 s75, s57, 160
  s_lshl_b32 s76, s56, 6
  s_add_u32 s60, s66, 0
  s_sub_u32 s61, s60, 11
  s_sub_u32 s62, s76, 3
  s_cmp_lt_u32 s60, 11
  s_cselect_b32 s77, s60, s61
  s_cselect_b32 s62, s62, s76
  s_lshl_b32 s61, s77, 6
  v_add_u32 v13, s61, v1
  v_mul_u32_u24 v14, 0xCCCD, v13
  v_lshrrev_b32 v14, 19, v14
  v_mul_u32_u24 v15, 10, v14
  v_sub_u32 v15, v13, v15
  v_add_u32 v14, s62, v14
  v_mul_lo_u32 v14, v14, s78
  v_lshl_add_u32 v14, v15, 4, v14
  v_add_u32 v14, s75, v14
  s_lshl_b32 s61, s60, 10
  s_add_u32 m0, s61, 131072
  s_cmp_lt_u32 s60, 11
  s_cbranch_scc0 gated_mix__ssm_conv_h3__grouped_kv_mqa__prompt_kernel_kvd_v0
  buffer_load_dwordx4 v14, s[20:23], 0 offen lds
  s_branch gated_mix__ssm_conv_h3__grouped_kv_mqa__prompt_kernel_kvd_e0
gated_mix__ssm_conv_h3__grouped_kv_mqa__prompt_kernel_kvd_v0:
  buffer_load_dwordx4 v14, s[24:27], 0 offen lds
gated_mix__ssm_conv_h3__grouped_kv_mqa__prompt_kernel_kvd_e0:
  s_add_u32 s60, s66, 3
  s_sub_u32 s61, s60, 11
  s_sub_u32 s62, s76, 3
  s_cmp_lt_u32 s60, 11
  s_cselect_b32 s77, s60, s61
  s_cselect_b32 s62, s62, s76
  s_lshl_b32 s61, s77, 6
  v_add_u32 v13, s61, v1
  v_mul_u32_u24 v14, 0xCCCD, v13
  v_lshrrev_b32 v14, 19, v14
  v_mul_u32_u24 v15, 10, v14
  v_sub_u32 v15, v13, v15
  v_add_u32 v14, s62, v14
  v_mul_lo_u32 v14, v14, s78
  v_lshl_add_u32 v14, v15, 4, v14
  v_add_u32 v14, s75, v14
  s_lshl_b32 s61, s60, 10
  s_add_u32 m0, s61, 131072
  s_cmp_lt_u32 s60, 11
  s_cbranch_scc0 gated_mix__ssm_conv_h3__grouped_kv_mqa__prompt_kernel_kvd_v1
  buffer_load_dwordx4 v14, s[20:23], 0 offen lds
  s_branch gated_mix__ssm_conv_h3__grouped_kv_mqa__prompt_kernel_kvd_e1
gated_mix__ssm_conv_h3__grouped_kv_mqa__prompt_kernel_kvd_v1:
  buffer_load_dwordx4 v14, s[24:27], 0 offen lds
gated_mix__ssm_conv_h3__grouped_kv_mqa__prompt_kernel_kvd_e1:
  s_add_u32 s60, s66, 6
  s_sub_u32 s61, s60, 11
  s_sub_u32 s62, s76, 3
  s_cmp_lt_u32 s60, 11
  s_cselect_b32 s77, s60, s61
  s_cselect_b32 s62, s62, s76
  s_lshl_b32 s61, s77, 6
  v_add_u32 v13, s61, v1
  v_mul_u32_u24 v14, 0xCCCD, v13
  v_lshrrev_b32 v14, 19, v14
  v_mul_u32_u24 v15, 10, v14
  v_sub_u32 v15, v13, v15
  v_add_u32 v14, s62, v14
  v_mul_lo_u32 v14, v14, s78
  v_lshl_add_u32 v14, v15, 4, v14
  v_add_u32 v14, s75, v14
  s_lshl_b32 s61, s60, 10
  s_add_u32 m0, s61, 131072
  s_cmp_lt_u32 s60, 11
  s_cbranch_scc0 gated_mix__ssm_conv_h3__grouped_kv_mqa__prompt_kernel_kvd_v2
  buffer_load_dwordx4 v14, s[20:23], 0 offen lds
  s_branch gated_mix__ssm_conv_h3__grouped_kv_mqa__prompt_kernel_kvd_e2
gated_mix__ssm_conv_h3__grouped_kv_mqa__prompt_kernel_kvd_v2:
  buffer_load_dwordx4 v14, s[24:27], 0 offen lds
gated_mix__ssm_conv_h3__grouped_kv_mqa__prompt_kernel_kvd_e2:
  s_add_u32 s60, s66, 9
  s_sub_u32 s61, s60, 11
  s_sub_u32 s62, s76, 3
  s_cmp_lt_u32 s60, 11
  s_cselect_b32 s77, s60, s61
  s_cselect_b32 s62, s62, s76
  s_lshl_b32 s61, s77, 6
  v_add_u32 v13, s61, v1
  v_mul_u32_u24 v14, 0xCCCD, v13
  v_lshrrev_b32 v14, 19, v14
  v_mul_u32_u24 v15, 10, v14
  v_sub_u32 v15, v13, v15
  v_add_u32 v14, s62, v14
  v_mul_lo_u32 v14, v14, s78
  v_lshl_add_u32 v14, v15, 4, v14
  v_add_u32 v14, s75, v14
  s_lshl_b32 s61, s60, 10
  s_add_u32 m0, s61, 131072
  s_cmp_lt_u32 s60, 11
  s_cbranch_scc0 gated_mix__ssm_conv_h3__grouped_kv_mqa__prompt_kernel_kvd_v3
  buffer_load_dwordx4 v14, s[20:23], 0 offen lds
  s_branch gated_mix__ssm_conv_h3__grouped_kv_mqa__prompt_kernel_kvd_e3
gated_mix__ssm_conv_h3__grouped_kv_mqa__prompt_kernel_kvd_v3:
  buffer_load_dwordx4 v14, s[24:27], 0 offen lds
gated_mix__ssm_conv_h3__grouped_kv_mqa__prompt_kernel_kvd_e3:
  s_add_u32 s60, s66, 12
  s_sub_u32 s61, s60, 11
  s_sub_u32 s62, s76, 3
  s_cmp_lt_u32 s60, 11
  s_cselect_b32 s77, s60, s61
  s_cselect_b32 s62, s62, s76
  s_lshl_b32 s61, s77, 6
  v_add_u32 v13, s61, v1
  v_mul_u32_u24 v14, 0xCCCD, v13
  v_lshrrev_b32 v14, 19, v14
  v_mul_u32_u24 v15, 10, v14
  v_sub_u32 v15, v13, v15
  v_add_u32 v14, s62, v14
  v_mul_lo_u32 v14, v14, s78
  v_lshl_add_u32 v14, v15, 4, v14
  v_add_u32 v14, s75, v14
  s_lshl_b32 s61, s60, 10
  s_add_u32 m0, s61, 131072
  s_cmp_lt_u32 s60, 11
  s_cbranch_scc0 gated_mix__ssm_conv_h3__grouped_kv_mqa__prompt_kernel_kvd_v4
  buffer_load_dwordx4 v14, s[20:23], 0 offen lds
  s_branch gated_mix__ssm_conv_h3__grouped_kv_mqa__prompt_kernel_kvd_e4
gated_mix__ssm_conv_h3__grouped_kv_mqa__prompt_kernel_kvd_v4:
  buffer_load_dwordx4 v14, s[24:27], 0 offen lds
gated_mix__ssm_conv_h3__grouped_kv_mqa__prompt_kernel_kvd_e4:
  s_add_u32 s60, s66, 15
  s_sub_u32 s61, s60, 11
  s_sub_u32 s62, s76, 3
  s_cmp_lt_u32 s60, 11
  s_cselect_b32 s77, s60, s61
  s_cselect_b32 s62, s62, s76
  s_lshl_b32 s61, s77, 6
  v_add_u32 v13, s61, v1
  v_mul_u32_u24 v14, 0xCCCD, v13
  v_lshrrev_b32 v14, 19, v14
  v_mul_u32_u24 v15, 10, v14
  v_sub_u32 v15, v13, v15
  v_add_u32 v14, s62, v14
  v_mul_lo_u32 v14, v14, s78
  v_lshl_add_u32 v14, v15, 4, v14
  v_add_u32 v14, s75, v14
  s_lshl_b32 s61, s60, 10
  s_add_u32 m0, s61, 131072
  s_cmp_lt_u32 s60, 11
  s_cbranch_scc0 gated_mix__ssm_conv_h3__grouped_kv_mqa__prompt_kernel_kvd_v5
  buffer_load_dwordx4 v14, s[20:23], 0 offen lds
  s_branch gated_mix__ssm_conv_h3__grouped_kv_mqa__prompt_kernel_kvd_e5
gated_mix__ssm_conv_h3__grouped_kv_mqa__prompt_kernel_kvd_v5:
  buffer_load_dwordx4 v14, s[24:27], 0 offen lds
gated_mix__ssm_conv_h3__grouped_kv_mqa__prompt_kernel_kvd_e5:
  s_add_u32 s60, s66, 18
  s_sub_u32 s61, s60, 11
  s_sub_u32 s62, s76, 3
  s_cmp_lt_u32 s60, 11
  s_cselect_b32 s77, s60, s61
  s_cselect_b32 s62, s62, s76
  s_lshl_b32 s61, s77, 6
  v_add_u32 v13, s61, v1
  v_mul_u32_u24 v14, 0xCCCD, v13
  v_lshrrev_b32 v14, 19, v14
  v_mul_u32_u24 v15, 10, v14
  v_sub_u32 v15, v13, v15
  v_add_u32 v14, s62, v14
  v_mul_lo_u32 v14, v14, s78
  v_lshl_add_u32 v14, v15, 4, v14
  v_add_u32 v14, s75, v14
  s_lshl_b32 s61, s60, 10
  s_add_u32 m0, s61, 131072
  s_cmp_lt_u32 s60, 11
  s_cbranch_scc0 gated_mix__ssm_conv_h3__grouped_kv_mqa__prompt_kernel_kvd_v6
  buffer_load_dwordx4 v14, s[20:23], 0 offen lds
  s_branch gated_mix__ssm_conv_h3__grouped_kv_mqa__prompt_kernel_kvd_e6
gated_mix__ssm_conv_h3__grouped_kv_mqa__prompt_kernel_kvd_v6:
  buffer_load_dwordx4 v14, s[24:27], 0 offen lds
gated_mix__ssm_conv_h3__grouped_kv_mqa__prompt_kernel_kvd_e6:
  s_mov_b64 exec, s[72:73]
  s_mul_i32 s61, s57, 640
  v_lshl_add_u32 v13, v18, 5, s61
  buffer_load_dwordx4 v[58:61], v13, s[28:31], 0 offen
  buffer_load_dwordx4 v[62:65], v13, s[28:31], 0 offen offset:16
  s_mul_i32 s60, s57, 80
  v_lshl_add_u32 v13, v18, 2, s60
  v_lshlrev_b32 v13, 12, v13
  v_sub_u32 v14, 7, v17
  v_lshl_add_u32 v13, v14, 4, v13
  s_sub_u32 s61, 31, s56
  s_lshl_b32 s61, s61, 7
  s_add_u32 s61, s61, 211968
  v_add_u32 v19, s61, v13
  s_mov_b64 exec, s[70:71]
  s_waitcnt vmcnt(2)
  v_mov_b32 v13, 162088
  v_mov_b32 v14, 1
  s_mov_b64 exec, 1
  ds_add_u32 v13, v14
  s_mov_b64 exec, -1
  s_cmp_eq_u32 s74, 0
  s_cbranch_scc1 gated_mix__ssm_conv_h3__grouped_kv_mqa__prompt_kernel_auxnoh
  v_lshlrev_b32 v16, 4, v1
  s_lshl_b32 s61, s67, 12
  buffer_load_dwordx4 v[68:71], v16, s[44:47], s61 offen offset:0
  buffer_load_dword v84, v16, s[44:47], s61 offen offset:16
  buffer_load_dwordx4 v[72:75], v16, s[44:47], s61 offen offset:1024
  buffer_load_dword v85, v16, s[44:47], s61 offen offset:1040
  buffer_load_dwordx4 v[76:79], v16, s[44:47], s61 offen offset:2048
  buffer_load_dword v86, v16, s[44:47], s61 offen offset:2064
  buffer_load_dwordx4 v[80:83], v16, s[44:47], s61 offen offset:3072
  buffer_load_dword v87, v16, s[44:47], s61 offen offset:3088
  s_lshl_b32 s62, s67, 1
  v_mov_b32 v15, 0
  buffer_load_ushort v88, v15, s[48:51], s62 offen
gated_mix__ssm_conv_h3__grouped_kv_mqa__prompt_kernel_auxnoh:
  v_mov_b32 v13, 162088
  s_mov_b32 s63, 0
gated_mix__ssm_conv_h3__grouped_kv_mqa__prompt_kernel_akvl:
  ds_read_b32 v14, v13
  s_waitcnt lgkmcnt(0)
  v_readfirstlane_b32 s69, v14
  s_nop 3
  s_cmp_ge_u32 s69, 3
  s_cbranch_scc1 gated_mix__ssm_conv_h3__grouped_kv_mqa__prompt_kernel_akvl_ok
  s_add_u32 s63, s63, 1
  s_cmp_gt_u32 s63, 1000000
  s_cbranch_scc1 gated_mix__ssm_conv_h3__grouped_kv_mqa__prompt_kernel_exit
  s_branch gated_mix__ssm_conv_h3__grouped_kv_mqa__prompt_kernel_akvl
gated_mix__ssm_conv_h3__grouped_kv_mqa__prompt_kernel_akvl_ok:
  s_mov_b64 exec, s[72:73]
  v_mul_u32_u24 v13, 1280, v17
  v_lshl_add_u32 v13, v18, 3, v13
  v_add_u32 v13, 131072, v13
  ds_read_b64 v[20:21], v13 offset:0
  ds_read_b64 v[22:23], v13 offset:160
  ds_read_b64 v[24:25], v13 offset:320
  ds_read_b64 v[26:27], v13 offset:480
  ds_read_b64 v[28:29], v13 offset:640
  ds_read_b64 v[30:31], v13 offset:800
  ds_read_b64 v[32:33], v13 offset:960
  ds_read_b64 v[34:35], v13 offset:1120
  ds_read_b64 v[36:37], v13 offset:1280
  ds_read_b64 v[38:39], v13 offset:1440
  ds_read_b64 v[40:41], v13 offset:1600
  ds_read_b64 v[42:43], v13 offset:11264
  ds_read_b64 v[44:45], v13 offset:11424
  ds_read_b64 v[46:47], v13 offset:11584
  ds_read_b64 v[48:49], v13 offset:11744
  ds_read_b64 v[50:51], v13 offset:11904
  ds_read_b64 v[52:53], v13 offset:12064
  ds_read_b64 v[54:55], v13 offset:12224
  ds_read_b64 v[56:57], v13 offset:12384
  s_waitcnt lgkmcnt(0)
  s_mov_b64 exec, s[70:71]
  v_mov_b32 v13, 162092
  v_mov_b32 v14, 1
  s_mov_b64 exec, 1
  ds_add_u32 v13, v14
  s_mov_b64 exec, -1
  s_mov_b64 exec, s[72:73]
  s_cmp_eq_u32 s74, 0
  s_cbranch_scc1 gated_mix__ssm_conv_h3__grouped_kv_mqa__prompt_kernel_auxw0
  s_waitcnt vmcnt(9)
  s_branch gated_mix__ssm_conv_h3__grouped_kv_mqa__prompt_kernel_auxw1
gated_mix__ssm_conv_h3__grouped_kv_mqa__prompt_kernel_auxw0:
  s_waitcnt vmcnt(0)
gated_mix__ssm_conv_h3__grouped_kv_mqa__prompt_kernel_auxw1:
  v_lshlrev_b32 v124, 16, v58
  v_and_b32 v125, 0xffff0000, v58
  v_lshlrev_b32 v126, 16, v59
  v_and_b32 v127, 0xffff0000, v59
  v_lshlrev_b32 v96, 16, v20
  v_lshlrev_b32 v97, 16, v22
  v_lshlrev_b32 v98, 16, v24
  v_lshlrev_b32 v99, 16, v26
  v_lshlrev_b32 v100, 16, v28
  v_lshlrev_b32 v101, 16, v30
  v_lshlrev_b32 v102, 16, v32
  v_lshlrev_b32 v103, 16, v34
  v_lshlrev_b32 v104, 16, v36
  v_lshlrev_b32 v105, 16, v38
  v_lshlrev_b32 v106, 16, v40
  v_lshlrev_b32 v108, 16, v42
  v_lshlrev_b32 v109, 16, v44
  v_lshlrev_b32 v110, 16, v46
  v_lshlrev_b32 v111, 16, v48
  v_lshlrev_b32 v112, 16, v50
  v_lshlrev_b32 v113, 16, v52
  v_lshlrev_b32 v114, 16, v54
  v_lshlrev_b32 v115, 16, v56
  v_mul_f32 v116, v99, v124
  v_mul_f32 v117, v100, v124
  v_mul_f32 v118, v101, v124
  v_mul_f32 v119, v102, v124
  v_mul_f32 v120, v103, v124
  v_mul_f32 v121, v104, v124
  v_mul_f32 v122, v105, v124
  v_mul_f32 v123, v106, v124
  v_fmac_f32 v116, v98, v125
  v_fmac_f32 v117, v99, v125
  v_fmac_f32 v118, v100, v125
  v_fmac_f32 v119, v101, v125
  v_fmac_f32 v120, v102, v125
  v_fmac_f32 v121, v103, v125
  v_fmac_f32 v122, v104, v125
  v_fmac_f32 v123, v105, v125
  v_fmac_f32 v116, v97, v126
  v_fmac_f32 v117, v98, v126
  v_fmac_f32 v118, v99, v126
  v_fmac_f32 v119, v100, v126
  v_fmac_f32 v120, v101, v126
  v_fmac_f32 v121, v102, v126
  v_fmac_f32 v122, v103, v126
  v_fmac_f32 v123, v104, v126
  v_fmac_f32 v116, v96, v127
  v_fmac_f32 v117, v97, v127
  v_fmac_f32 v118, v98, v127
  v_fmac_f32 v119, v99, v127
  v_fmac_f32 v120, v100, v127
  v_fmac_f32 v121, v101, v127
  v_fmac_f32 v122, v102, v127
  v_fmac_f32 v123, v103, v127
  v_mul_f32 v116, v116, v108
  v_mul_f32 v117, v117, v109
  v_mul_f32 v118, v118, v110
  v_mul_f32 v119, v119, v111
  v_mul_f32 v120, v120, v112
  v_mul_f32 v121, v121, v113
  v_mul_f32 v122, v122, v114
  v_mul_f32 v123, v123, v115
  v_cvt_pk_bf16_f32 v128, v123, v122
  v_cvt_pk_bf16_f32 v129, v121, v120
  v_cvt_pk_bf16_f32 v130, v119, v118
  v_cvt_pk_bf16_f32 v131, v117, v116
  buffer_store_dwordx4 v[128:131], v19, s[16:19], 0 offen sc1
  v_add_u32 v19, 4096, v19
  v_lshlrev_b32 v124, 16, v60
  v_and_b32 v125, 0xffff0000, v60
  v_lshlrev_b32 v126, 16, v61
  v_and_b32 v127, 0xffff0000, v61
  v_and_b32 v96, 0xffff0000, v20
  v_and_b32 v97, 0xffff0000, v22
  v_and_b32 v98, 0xffff0000, v24
  v_and_b32 v99, 0xffff0000, v26
  v_and_b32 v100, 0xffff0000, v28
  v_and_b32 v101, 0xffff0000, v30
  v_and_b32 v102, 0xffff0000, v32
  v_and_b32 v103, 0xffff0000, v34
  v_and_b32 v104, 0xffff0000, v36
  v_and_b32 v105, 0xffff0000, v38
  v_and_b32 v106, 0xffff0000, v40
  v_and_b32 v108, 0xffff0000, v42
  v_and_b32 v109, 0xffff0000, v44
  v_and_b32 v110, 0xffff0000, v46
  v_and_b32 v111, 0xffff0000, v48
  v_and_b32 v112, 0xffff0000, v50
  v_and_b32 v113, 0xffff0000, v52
  v_and_b32 v114, 0xffff0000, v54
  v_and_b32 v115, 0xffff0000, v56
  v_mul_f32 v116, v99, v124
  v_mul_f32 v117, v100, v124
  v_mul_f32 v118, v101, v124
  v_mul_f32 v119, v102, v124
  v_mul_f32 v120, v103, v124
  v_mul_f32 v121, v104, v124
  v_mul_f32 v122, v105, v124
  v_mul_f32 v123, v106, v124
  v_fmac_f32 v116, v98, v125
  v_fmac_f32 v117, v99, v125
  v_fmac_f32 v118, v100, v125
  v_fmac_f32 v119, v101, v125
  v_fmac_f32 v120, v102, v125
  v_fmac_f32 v121, v103, v125
  v_fmac_f32 v122, v104, v125
  v_fmac_f32 v123, v105, v125
  v_fmac_f32 v116, v97, v126
  v_fmac_f32 v117, v98, v126
  v_fmac_f32 v118, v99, v126
  v_fmac_f32 v119, v100, v126
  v_fmac_f32 v120, v101, v126
  v_fmac_f32 v121, v102, v126
  v_fmac_f32 v122, v103, v126
  v_fmac_f32 v123, v104, v126
  v_fmac_f32 v116, v96, v127
  v_fmac_f32 v117, v97, v127
  v_fmac_f32 v118, v98, v127
  v_fmac_f32 v119, v99, v127
  v_fmac_f32 v120, v100, v127
  v_fmac_f32 v121, v101, v127
  v_fmac_f32 v122, v102, v127
  v_fmac_f32 v123, v103, v127
  v_mul_f32 v116, v116, v108
  v_mul_f32 v117, v117, v109
  v_mul_f32 v118, v118, v110
  v_mul_f32 v119, v119, v111
  v_mul_f32 v120, v120, v112
  v_mul_f32 v121, v121, v113
  v_mul_f32 v122, v122, v114
  v_mul_f32 v123, v123, v115
  v_cvt_pk_bf16_f32 v132, v123, v122
  v_cvt_pk_bf16_f32 v133, v121, v120
  v_cvt_pk_bf16_f32 v134, v119, v118
  v_cvt_pk_bf16_f32 v135, v117, v116
  buffer_store_dwordx4 v[132:135], v19, s[16:19], 0 offen sc1
  v_add_u32 v19, 4096, v19
  v_lshlrev_b32 v124, 16, v62
  v_and_b32 v125, 0xffff0000, v62
  v_lshlrev_b32 v126, 16, v63
  v_and_b32 v127, 0xffff0000, v63
  v_lshlrev_b32 v96, 16, v21
  v_lshlrev_b32 v97, 16, v23
  v_lshlrev_b32 v98, 16, v25
  v_lshlrev_b32 v99, 16, v27
  v_lshlrev_b32 v100, 16, v29
  v_lshlrev_b32 v101, 16, v31
  v_lshlrev_b32 v102, 16, v33
  v_lshlrev_b32 v103, 16, v35
  v_lshlrev_b32 v104, 16, v37
  v_lshlrev_b32 v105, 16, v39
  v_lshlrev_b32 v106, 16, v41
  v_lshlrev_b32 v108, 16, v43
  v_lshlrev_b32 v109, 16, v45
  v_lshlrev_b32 v110, 16, v47
  v_lshlrev_b32 v111, 16, v49
  v_lshlrev_b32 v112, 16, v51
  v_lshlrev_b32 v113, 16, v53
  v_lshlrev_b32 v114, 16, v55
  v_lshlrev_b32 v115, 16, v57
  v_mul_f32 v116, v99, v124
  v_mul_f32 v117, v100, v124
  v_mul_f32 v118, v101, v124
  v_mul_f32 v119, v102, v124
  v_mul_f32 v120, v103, v124
  v_mul_f32 v121, v104, v124
  v_mul_f32 v122, v105, v124
  v_mul_f32 v123, v106, v124
  v_fmac_f32 v116, v98, v125
  v_fmac_f32 v117, v99, v125
  v_fmac_f32 v118, v100, v125
  v_fmac_f32 v119, v101, v125
  v_fmac_f32 v120, v102, v125
  v_fmac_f32 v121, v103, v125
  v_fmac_f32 v122, v104, v125
  v_fmac_f32 v123, v105, v125
  v_fmac_f32 v116, v97, v126
  v_fmac_f32 v117, v98, v126
  v_fmac_f32 v118, v99, v126
  v_fmac_f32 v119, v100, v126
  v_fmac_f32 v120, v101, v126
  v_fmac_f32 v121, v102, v126
  v_fmac_f32 v122, v103, v126
  v_fmac_f32 v123, v104, v126
  v_fmac_f32 v116, v96, v127
  v_fmac_f32 v117, v97, v127
  v_fmac_f32 v118, v98, v127
  v_fmac_f32 v119, v99, v127
  v_fmac_f32 v120, v100, v127
  v_fmac_f32 v121, v101, v127
  v_fmac_f32 v122, v102, v127
  v_fmac_f32 v123, v103, v127
  v_mul_f32 v116, v116, v108
  v_mul_f32 v117, v117, v109
  v_mul_f32 v118, v118, v110
  v_mul_f32 v119, v119, v111
  v_mul_f32 v120, v120, v112
  v_mul_f32 v121, v121, v113
  v_mul_f32 v122, v122, v114
  v_mul_f32 v123, v123, v115
  v_cvt_pk_bf16_f32 v136, v123, v122
  v_cvt_pk_bf16_f32 v137, v121, v120
  v_cvt_pk_bf16_f32 v138, v119, v118
  v_cvt_pk_bf16_f32 v139, v117, v116
  buffer_store_dwordx4 v[136:139], v19, s[16:19], 0 offen sc1
  v_add_u32 v19, 4096, v19
  v_lshlrev_b32 v124, 16, v64
  v_and_b32 v125, 0xffff0000, v64
  v_lshlrev_b32 v126, 16, v65
  v_and_b32 v127, 0xffff0000, v65
  v_and_b32 v96, 0xffff0000, v21
  v_and_b32 v97, 0xffff0000, v23
  v_and_b32 v98, 0xffff0000, v25
  v_and_b32 v99, 0xffff0000, v27
  v_and_b32 v100, 0xffff0000, v29
  v_and_b32 v101, 0xffff0000, v31
  v_and_b32 v102, 0xffff0000, v33
  v_and_b32 v103, 0xffff0000, v35
  v_and_b32 v104, 0xffff0000, v37
  v_and_b32 v105, 0xffff0000, v39
  v_and_b32 v106, 0xffff0000, v41
  v_and_b32 v108, 0xffff0000, v43
  v_and_b32 v109, 0xffff0000, v45
  v_and_b32 v110, 0xffff0000, v47
  v_and_b32 v111, 0xffff0000, v49
  v_and_b32 v112, 0xffff0000, v51
  v_and_b32 v113, 0xffff0000, v53
  v_and_b32 v114, 0xffff0000, v55
  v_and_b32 v115, 0xffff0000, v57
  v_mul_f32 v116, v99, v124
  v_mul_f32 v117, v100, v124
  v_mul_f32 v118, v101, v124
  v_mul_f32 v119, v102, v124
  v_mul_f32 v120, v103, v124
  v_mul_f32 v121, v104, v124
  v_mul_f32 v122, v105, v124
  v_mul_f32 v123, v106, v124
  v_fmac_f32 v116, v98, v125
  v_fmac_f32 v117, v99, v125
  v_fmac_f32 v118, v100, v125
  v_fmac_f32 v119, v101, v125
  v_fmac_f32 v120, v102, v125
  v_fmac_f32 v121, v103, v125
  v_fmac_f32 v122, v104, v125
  v_fmac_f32 v123, v105, v125
  v_fmac_f32 v116, v97, v126
  v_fmac_f32 v117, v98, v126
  v_fmac_f32 v118, v99, v126
  v_fmac_f32 v119, v100, v126
  v_fmac_f32 v120, v101, v126
  v_fmac_f32 v121, v102, v126
  v_fmac_f32 v122, v103, v126
  v_fmac_f32 v123, v104, v126
  v_fmac_f32 v116, v96, v127
  v_fmac_f32 v117, v97, v127
  v_fmac_f32 v118, v98, v127
  v_fmac_f32 v119, v99, v127
  v_fmac_f32 v120, v100, v127
  v_fmac_f32 v121, v101, v127
  v_fmac_f32 v122, v102, v127
  v_fmac_f32 v123, v103, v127
  v_mul_f32 v116, v116, v108
  v_mul_f32 v117, v117, v109
  v_mul_f32 v118, v118, v110
  v_mul_f32 v119, v119, v111
  v_mul_f32 v120, v120, v112
  v_mul_f32 v121, v121, v113
  v_mul_f32 v122, v122, v114
  v_mul_f32 v123, v123, v115
  v_cvt_pk_bf16_f32 v140, v123, v122
  v_cvt_pk_bf16_f32 v141, v121, v120
  v_cvt_pk_bf16_f32 v142, v119, v118
  v_cvt_pk_bf16_f32 v143, v117, v116
  buffer_store_dwordx4 v[140:143], v19, s[16:19], 0 offen sc1
  s_mov_b64 exec, s[70:71]
  s_waitcnt vmcnt(0)
  s_lshl_b32 s64, s57, 7
  s_lshl_b32 s61, s56, 2
  s_add_u32 s64, s64, s61
  s_add_u32 s64, s64, 9216
  v_mov_b32 v13, 161864
  v_mov_b32 v14, 1
  s_mov_b64 exec, 1
  ds_add_rtn_u32 v14, v13, v14
  s_waitcnt lgkmcnt(0)
  v_readfirstlane_b32 s60, v14
  s_mov_b64 exec, -1
  s_nop 3
  s_add_u32 s60, s60, 1
  s_cmp_lg_u32 s60, 3
  s_cbranch_scc1 gated_mix__ssm_conv_h3__grouped_kv_mqa__prompt_kernel_kvt_nsig
  v_mul_u32_u24 v13, 0, v1
  v_mov_b32 v14, s98
  s_mov_b64 exec, 1
  buffer_store_dword v14, v13, s[16:19], s64 offen sc1
  s_mov_b64 exec, -1
gated_mix__ssm_conv_h3__grouped_kv_mqa__prompt_kernel_kvt_nsig:
  s_cmp_eq_u32 s74, 0
  s_cbranch_scc1 gated_mix__ssm_conv_h3__grouped_kv_mqa__prompt_kernel_exit
  v_mov_b32 v13, 162056
  s_mov_b32 s63, 0
gated_mix__ssm_conv_h3__grouped_kv_mqa__prompt_kernel_qfree:
  ds_read_b32 v14, v13
  s_waitcnt lgkmcnt(0)
  v_readfirstlane_b32 s69, v14
  s_nop 3
  s_cmp_ge_u32 s69, 8
  s_cbranch_scc1 gated_mix__ssm_conv_h3__grouped_kv_mqa__prompt_kernel_qfree_ok
  s_add_u32 s63, s63, 1
  s_cmp_gt_u32 s63, 1000000
  s_cbranch_scc1 gated_mix__ssm_conv_h3__grouped_kv_mqa__prompt_kernel_exit
  s_branch gated_mix__ssm_conv_h3__grouped_kv_mqa__prompt_kernel_qfree
gated_mix__ssm_conv_h3__grouped_kv_mqa__prompt_kernel_qfree_ok:
  s_mul_i32 s65, s66, 12912
  v_lshlrev_b32 v16, 4, v1
  v_add_u32 v17, s65, v16
  v_mov_b32 v20, 0
  v_mov_b32 v21, 0
  v_mov_b32 v22, 0
  v_mov_b32 v23, 0
  s_mov_b64 exec, 0xffffffff
  ds_write_b128 v17, v[20:23] offset:12400
  s_mov_b64 exec, 0xff
  v_lshlrev_b32 v18, 2, v1
  v_add_u32 v18, s65, v18
  ds_write_b32 v18, v20 offset:0
  ds_write_b32 v18, v20 offset:4164
  s_mov_b64 exec, -1
  v_lshlrev_b32 v88, 16, v88
  v_lshlrev_b32 v24, 16, v68
  v_add_f32 v24, v24, v88
  v_cvt_pk_bf16_f32 v24, v24, v24
  v_and_b32 v24, 0xffff, v24
  v_and_b32 v25, 0xffff0000, v68
  v_or_b32 v24, v24, v25
  v_cmp_eq_u32 vcc, 0, v1
  s_nop 1
  v_cndmask_b32 v68, v68, v24, vcc
  v_lshlrev_b32 v24, 16, v68
  s_and_saveexec_b64 s[62:63], vcc
  v_mov_b32 v25, s65
  ds_write_b32 v25, v24 offset:4192
  s_mov_b64 exec, s[62:63]
  ds_write_b128 v17, v[68:71] offset:32
  v_alignbit_b32 v24, v69, v68, 16
  v_alignbit_b32 v25, v70, v69, 16
  v_alignbit_b32 v26, v71, v70, 16
  v_alignbit_b32 v27, v84, v71, 16
  v_add_u32 v19, 4196, v17
  ds_write2_b32 v19, v24, v25 offset0:0 offset1:1
  ds_write2_b32 v19, v26, v27 offset0:2 offset1:3
  ds_write_b128 v17, v[72:75] offset:1056
  v_alignbit_b32 v24, v73, v72, 16
  v_alignbit_b32 v25, v74, v73, 16
  v_alignbit_b32 v26, v75, v74, 16
  v_alignbit_b32 v27, v85, v75, 16
  v_add_u32 v19, 5220, v17
  ds_write2_b32 v19, v24, v25 offset0:0 offset1:1
  ds_write2_b32 v19, v26, v27 offset0:2 offset1:3
  ds_write_b128 v17, v[76:79] offset:2080
  v_alignbit_b32 v24, v77, v76, 16
  v_alignbit_b32 v25, v78, v77, 16
  v_alignbit_b32 v26, v79, v78, 16
  v_alignbit_b32 v27, v86, v79, 16
  v_add_u32 v19, 6244, v17
  ds_write2_b32 v19, v24, v25 offset0:0 offset1:1
  ds_write2_b32 v19, v26, v27 offset0:2 offset1:3
  ds_write_b128 v17, v[80:83] offset:3104
  v_alignbit_b32 v24, v81, v80, 16
  v_alignbit_b32 v25, v82, v81, 16
  v_alignbit_b32 v26, v83, v82, 16
  v_alignbit_b32 v27, v87, v83, 16
  v_add_u32 v19, 7268, v17
  ds_write2_b32 v19, v24, v25 offset0:0 offset1:1
  ds_write2_b32 v19, v26, v27 offset0:2 offset1:3
  v_and_b32 v2, 15, v1
  v_lshrrev_b32 v3, 4, v1
  v_add_u32 v13, 1, v2
  v_and_b32 v14, 1, v13
  v_mul_u32_u24 v14, 4164, v14
  v_lshrrev_b32 v13, 1, v13
  v_lshl_add_u32 v13, v3, 2, v13
  v_lshl_add_u32 v4, v13, 2, v14
  v_add_u32 v4, s65, v4
  v_add_u32 v5, 512, v4
  v_add_u32 v6, 1024, v4
  v_add_u32 v7, 1536, v4
  v_add_u32 v8, 2048, v4
  v_add_u32 v9, 2560, v4
  v_add_u32 v10, 3072, v4
  v_add_u32 v11, 3584, v4
  v_lshrrev_b32 v13, 1, v3
  v_sub_u32 v13, v13, v2
  v_add_u32 v13, 15, v13
  v_lshlrev_b32 v13, 5, v13
  v_and_b32 v14, 1, v3
  v_lshl_add_u32 v13, v14, 4, v13
  v_add_u32 v12, s65, v13
  v_add_u32 v12, 8304, v12
  s_waitcnt lgkmcnt(0)
  s_lshl_b32 s64, s57, 7
  s_add_u32 s64, s64, 9216
  v_lshlrev_b32 v13, 2, v1
  s_mov_b32 s63, 0
  s_mov_b64 exec, 0xffffffff
gated_mix__ssm_conv_h3__grouped_kv_mqa__prompt_kernel_pu_again:
  buffer_load_dword v14, v13, s[16:19], s64 offen sc1
  s_waitcnt vmcnt(0)
  v_cmp_ne_u32 vcc, s98, v14
  s_nop 4
  s_cmp_eq_u64 vcc, 0
  s_cbranch_scc1 gated_mix__ssm_conv_h3__grouped_kv_mqa__prompt_kernel_pu_ok
  s_sleep 4
  s_add_u32 s63, s63, 1
  s_cmp_gt_u32 s63, 100000
  s_cbranch_scc1 gated_mix__ssm_conv_h3__grouped_kv_mqa__prompt_kernel_exit
  s_branch gated_mix__ssm_conv_h3__grouped_kv_mqa__prompt_kernel_pu_again
gated_mix__ssm_conv_h3__grouped_kv_mqa__prompt_kernel_pu_ok:
  s_mov_b64 exec, -1
  s_lshl_b32 s60, s67, 12
  s_add_u32 s60, s60, 211968
  v_lshlrev_b32 v13, 4, v1
  s_add_u32 m0, s65, 8304
  s_nop 0
  buffer_load_dwordx4 v13, s[16:19], s60 offen sc1 lds
  s_add_u32 s60, s60, 1024
  s_add_u32 m0, m0, 1024
  s_nop 0
  buffer_load_dwordx4 v13, s[16:19], s60 offen sc1 lds
  s_add_u32 s60, s60, 1024
  s_add_u32 m0, m0, 1024
  s_nop 0
  buffer_load_dwordx4 v13, s[16:19], s60 offen sc1 lds
  s_add_u32 s60, s60, 1024
  s_add_u32 m0, m0, 1024
  s_nop 0
  buffer_load_dwordx4 v13, s[16:19], s60 offen sc1 lds
  v_mov_b32 v16, 0
  v_mov_b32 v17, 0
  v_mov_b32 v18, 0
  v_mov_b32 v19, 0
  v_mov_b32 v20, 0
  v_mov_b32 v21, 0
  v_mov_b32 v22, 0
  v_mov_b32 v23, 0
  v_mov_b32 v24, 0
  v_mov_b32 v25, 0
  v_mov_b32 v26, 0
  v_mov_b32 v27, 0
  v_mov_b32 v28, 0
  v_mov_b32 v29, 0
  v_mov_b32 v30, 0
  v_mov_b32 v31, 0
  v_mov_b32 v32, 0
  v_mov_b32 v33, 0
  v_mov_b32 v34, 0
  v_mov_b32 v35, 0
  v_mov_b32 v36, 0
  v_mov_b32 v37, 0
  v_mov_b32 v38, 0
  v_mov_b32 v39, 0
  v_mov_b32 v40, 0
  v_mov_b32 v41, 0
  v_mov_b32 v42, 0
  v_mov_b32 v43, 0
  v_mov_b32 v44, 0
  v_mov_b32 v45, 0
  v_mov_b32 v46, 0
  v_mov_b32 v47, 0
  s_waitcnt vmcnt(0)
  s_setprio 1
  ds_read_b128 v[108:111], v12 offset:0
  ds_read2_b32 v[48:49], v4 offset0:0 offset1:1
  ds_read2_b32 v[50:51], v4 offset0:2 offset1:3
  ds_read_b128 v[104:107], v12 offset:512
  ds_read2_b32 v[52:53], v5 offset0:0 offset1:1
  ds_read2_b32 v[54:55], v5 offset0:2 offset1:3
  ds_read_b128 v[100:103], v12 offset:1024
  ds_read2_b32 v[56:57], v6 offset0:0 offset1:1
  ds_read2_b32 v[58:59], v6 offset0:2 offset1:3
  ds_read_b128 v[96:99], v12 offset:1536
  ds_read2_b32 v[60:61], v7 offset0:0 offset1:1
  ds_read2_b32 v[62:63], v7 offset0:2 offset1:3
  ds_read_b128 v[92:95], v12 offset:2048
  ds_read2_b32 v[64:65], v8 offset0:0 offset1:1
  ds_read2_b32 v[66:67], v8 offset0:2 offset1:3
  ds_read_b128 v[88:91], v12 offset:2560
  ds_read2_b32 v[68:69], v9 offset0:0 offset1:1
  ds_read2_b32 v[70:71], v9 offset0:2 offset1:3
  ds_read_b128 v[84:87], v12 offset:3072
  ds_read2_b32 v[72:73], v10 offset0:0 offset1:1
  ds_read2_b32 v[74:75], v10 offset0:2 offset1:3
  ds_read_b128 v[80:83], v12 offset:3584
  ds_read2_b32 v[76:77], v11 offset0:0 offset1:1
  ds_read2_b32 v[78:79], v11 offset0:2 offset1:3
  s_waitcnt lgkmcnt(15)
  v_mfma_f32_16x16x32_bf16 v[44:47], v[48:51], v[108:111], v[44:47]
  v_mfma_f32_16x16x32_bf16 v[40:43], v[48:51], v[104:107], v[40:43]
  v_mfma_f32_16x16x32_bf16 v[36:39], v[48:51], v[100:103], v[36:39]
  s_waitcnt lgkmcnt(14)
  v_mfma_f32_16x16x32_bf16 v[32:35], v[48:51], v[96:99], v[32:35]
  s_waitcnt lgkmcnt(11)
  v_mfma_f32_16x16x32_bf16 v[28:31], v[48:51], v[92:95], v[28:31]
  s_waitcnt lgkmcnt(8)
  v_mfma_f32_16x16x32_bf16 v[24:27], v[48:51], v[88:91], v[24:27]
  s_waitcnt lgkmcnt(5)
  v_mfma_f32_16x16x32_bf16 v[20:23], v[48:51], v[84:87], v[20:23]
  s_waitcnt lgkmcnt(2)
  v_mfma_f32_16x16x32_bf16 v[16:19], v[48:51], v[80:83], v[16:19]
  ds_read2_b32 v[48:49], v4 offset0:16 offset1:17
  ds_read2_b32 v[50:51], v4 offset0:18 offset1:19
  ds_read_b128 v[108:111], v12 offset:64
  v_mfma_f32_16x16x32_bf16 v[44:47], v[52:55], v[104:107], v[44:47]
  v_mfma_f32_16x16x32_bf16 v[40:43], v[52:55], v[100:103], v[40:43]
  v_mfma_f32_16x16x32_bf16 v[36:39], v[52:55], v[96:99], v[36:39]
  v_mfma_f32_16x16x32_bf16 v[32:35], v[52:55], v[92:95], v[32:35]
  v_mfma_f32_16x16x32_bf16 v[28:31], v[52:55], v[88:91], v[28:31]
  v_mfma_f32_16x16x32_bf16 v[24:27], v[52:55], v[84:87], v[24:27]
  v_mfma_f32_16x16x32_bf16 v[20:23], v[52:55], v[80:83], v[20:23]
  ds_read2_b32 v[52:53], v5 offset0:16 offset1:17
  ds_read2_b32 v[54:55], v5 offset0:18 offset1:19
  ds_read_b128 v[104:107], v12 offset:576
  v_mfma_f32_16x16x32_bf16 v[44:47], v[56:59], v[100:103], v[44:47]
  v_mfma_f32_16x16x32_bf16 v[40:43], v[56:59], v[96:99], v[40:43]
  v_mfma_f32_16x16x32_bf16 v[36:39], v[56:59], v[92:95], v[36:39]
  v_mfma_f32_16x16x32_bf16 v[32:35], v[56:59], v[88:91], v[32:35]
  v_mfma_f32_16x16x32_bf16 v[28:31], v[56:59], v[84:87], v[28:31]
  v_mfma_f32_16x16x32_bf16 v[24:27], v[56:59], v[80:83], v[24:27]
  ds_read2_b32 v[56:57], v6 offset0:16 offset1:17
  ds_read2_b32 v[58:59], v6 offset0:18 offset1:19
  ds_read_b128 v[100:103], v12 offset:1088
  v_mfma_f32_16x16x32_bf16 v[44:47], v[60:63], v[96:99], v[44:47]
  v_mfma_f32_16x16x32_bf16 v[40:43], v[60:63], v[92:95], v[40:43]
  v_mfma_f32_16x16x32_bf16 v[36:39], v[60:63], v[88:91], v[36:39]
  v_mfma_f32_16x16x32_bf16 v[32:35], v[60:63], v[84:87], v[32:35]
  v_mfma_f32_16x16x32_bf16 v[28:31], v[60:63], v[80:83], v[28:31]
  ds_read2_b32 v[60:61], v7 offset0:16 offset1:17
  ds_read2_b32 v[62:63], v7 offset0:18 offset1:19
  ds_read_b128 v[96:99], v12 offset:1600
  v_mfma_f32_16x16x32_bf16 v[44:47], v[64:67], v[92:95], v[44:47]
  v_mfma_f32_16x16x32_bf16 v[40:43], v[64:67], v[88:91], v[40:43]
  v_mfma_f32_16x16x32_bf16 v[36:39], v[64:67], v[84:87], v[36:39]
  v_mfma_f32_16x16x32_bf16 v[32:35], v[64:67], v[80:83], v[32:35]
  ds_read2_b32 v[64:65], v8 offset0:16 offset1:17
  ds_read2_b32 v[66:67], v8 offset0:18 offset1:19
  ds_read_b128 v[92:95], v12 offset:2112
  v_mfma_f32_16x16x32_bf16 v[44:47], v[68:71], v[88:91], v[44:47]
  v_mfma_f32_16x16x32_bf16 v[40:43], v[68:71], v[84:87], v[40:43]
  v_mfma_f32_16x16x32_bf16 v[36:39], v[68:71], v[80:83], v[36:39]
  ds_read2_b32 v[68:69], v9 offset0:16 offset1:17
  ds_read2_b32 v[70:71], v9 offset0:18 offset1:19
  ds_read_b128 v[88:91], v12 offset:2624
  v_mfma_f32_16x16x32_bf16 v[44:47], v[72:75], v[84:87], v[44:47]
  v_mfma_f32_16x16x32_bf16 v[40:43], v[72:75], v[80:83], v[40:43]
  ds_read2_b32 v[72:73], v10 offset0:16 offset1:17
  ds_read2_b32 v[74:75], v10 offset0:18 offset1:19
  ds_read_b128 v[84:87], v12 offset:3136
  s_waitcnt lgkmcnt(15)
  v_mfma_f32_16x16x32_bf16 v[44:47], v[76:79], v[80:83], v[44:47]
  ds_read2_b32 v[76:77], v11 offset0:16 offset1:17
  ds_read2_b32 v[78:79], v11 offset0:18 offset1:19
  ds_read_b128 v[80:83], v12 offset:3648
  v_mfma_f32_16x16x32_bf16 v[44:47], v[48:51], v[108:111], v[44:47]
  v_mfma_f32_16x16x32_bf16 v[40:43], v[48:51], v[104:107], v[40:43]
  s_waitcnt lgkmcnt(15)
  v_mfma_f32_16x16x32_bf16 v[36:39], v[48:51], v[100:103], v[36:39]
  s_waitcnt lgkmcnt(12)
  v_mfma_f32_16x16x32_bf16 v[32:35], v[48:51], v[96:99], v[32:35]
  s_waitcnt lgkmcnt(9)
  v_mfma_f32_16x16x32_bf16 v[28:31], v[48:51], v[92:95], v[28:31]
  s_waitcnt lgkmcnt(6)
  v_mfma_f32_16x16x32_bf16 v[24:27], v[48:51], v[88:91], v[24:27]
  s_waitcnt lgkmcnt(3)
  v_mfma_f32_16x16x32_bf16 v[20:23], v[48:51], v[84:87], v[20:23]
  s_waitcnt lgkmcnt(0)
  v_mfma_f32_16x16x32_bf16 v[16:19], v[48:51], v[80:83], v[16:19]
  ds_read2_b32 v[48:49], v4 offset0:32 offset1:33
  ds_read2_b32 v[50:51], v4 offset0:34 offset1:35
  ds_read_b128 v[108:111], v12 offset:128
  v_mfma_f32_16x16x32_bf16 v[44:47], v[52:55], v[104:107], v[44:47]
  v_mfma_f32_16x16x32_bf16 v[40:43], v[52:55], v[100:103], v[40:43]
  v_mfma_f32_16x16x32_bf16 v[36:39], v[52:55], v[96:99], v[36:39]
  v_mfma_f32_16x16x32_bf16 v[32:35], v[52:55], v[92:95], v[32:35]
  v_mfma_f32_16x16x32_bf16 v[28:31], v[52:55], v[88:91], v[28:31]
  v_mfma_f32_16x16x32_bf16 v[24:27], v[52:55], v[84:87], v[24:27]
  v_mfma_f32_16x16x32_bf16 v[20:23], v[52:55], v[80:83], v[20:23]
  ds_read2_b32 v[52:53], v5 offset0:32 offset1:33
  ds_read2_b32 v[54:55], v5 offset0:34 offset1:35
  ds_read_b128 v[104:107], v12 offset:640
  v_mfma_f32_16x16x32_bf16 v[44:47], v[56:59], v[100:103], v[44:47]
  v_mfma_f32_16x16x32_bf16 v[40:43], v[56:59], v[96:99], v[40:43]
  v_mfma_f32_16x16x32_bf16 v[36:39], v[56:59], v[92:95], v[36:39]
  v_mfma_f32_16x16x32_bf16 v[32:35], v[56:59], v[88:91], v[32:35]
  v_mfma_f32_16x16x32_bf16 v[28:31], v[56:59], v[84:87], v[28:31]
  v_mfma_f32_16x16x32_bf16 v[24:27], v[56:59], v[80:83], v[24:27]
  ds_read2_b32 v[56:57], v6 offset0:32 offset1:33
  ds_read2_b32 v[58:59], v6 offset0:34 offset1:35
  ds_read_b128 v[100:103], v12 offset:1152
  v_mfma_f32_16x16x32_bf16 v[44:47], v[60:63], v[96:99], v[44:47]
  v_mfma_f32_16x16x32_bf16 v[40:43], v[60:63], v[92:95], v[40:43]
  v_mfma_f32_16x16x32_bf16 v[36:39], v[60:63], v[88:91], v[36:39]
  v_mfma_f32_16x16x32_bf16 v[32:35], v[60:63], v[84:87], v[32:35]
  v_mfma_f32_16x16x32_bf16 v[28:31], v[60:63], v[80:83], v[28:31]
  ds_read2_b32 v[60:61], v7 offset0:32 offset1:33
  ds_read2_b32 v[62:63], v7 offset0:34 offset1:35
  ds_read_b128 v[96:99], v12 offset:1664
  v_mfma_f32_16x16x32_bf16 v[44:47], v[64:67], v[92:95], v[44:47]
  v_mfma_f32_16x16x32_bf16 v[40:43], v[64:67], v[88:91], v[40:43]
  v_mfma_f32_16x16x32_bf16 v[36:39], v[64:67], v[84:87], v[36:39]
  v_mfma_f32_16x16x32_bf16 v[32:35], v[64:67], v[80:83], v[32:35]
  ds_read2_b32 v[64:65], v8 offset0:32 offset1:33
  ds_read2_b32 v[66:67], v8 offset0:34 offset1:35
  ds_read_b128 v[92:95], v12 offset:2176
  v_mfma_f32_16x16x32_bf16 v[44:47], v[68:71], v[88:91], v[44:47]
  v_mfma_f32_16x16x32_bf16 v[40:43], v[68:71], v[84:87], v[40:43]
  v_mfma_f32_16x16x32_bf16 v[36:39], v[68:71], v[80:83], v[36:39]
  ds_read2_b32 v[68:69], v9 offset0:32 offset1:33
  ds_read2_b32 v[70:71], v9 offset0:34 offset1:35
  ds_read_b128 v[88:91], v12 offset:2688
  v_mfma_f32_16x16x32_bf16 v[44:47], v[72:75], v[84:87], v[44:47]
  v_mfma_f32_16x16x32_bf16 v[40:43], v[72:75], v[80:83], v[40:43]
  ds_read2_b32 v[72:73], v10 offset0:32 offset1:33
  ds_read2_b32 v[74:75], v10 offset0:34 offset1:35
  ds_read_b128 v[84:87], v12 offset:3200
  v_mfma_f32_16x16x32_bf16 v[44:47], v[76:79], v[80:83], v[44:47]
  ds_read2_b32 v[76:77], v11 offset0:32 offset1:33
  ds_read2_b32 v[78:79], v11 offset0:34 offset1:35
  ds_read_b128 v[80:83], v12 offset:3712
  s_waitcnt lgkmcnt(15)
  v_mfma_f32_16x16x32_bf16 v[44:47], v[48:51], v[108:111], v[44:47]
  v_mfma_f32_16x16x32_bf16 v[40:43], v[48:51], v[104:107], v[40:43]
  v_mfma_f32_16x16x32_bf16 v[36:39], v[48:51], v[100:103], v[36:39]
  s_waitcnt lgkmcnt(12)
  v_mfma_f32_16x16x32_bf16 v[32:35], v[48:51], v[96:99], v[32:35]
  s_waitcnt lgkmcnt(9)
  v_mfma_f32_16x16x32_bf16 v[28:31], v[48:51], v[92:95], v[28:31]
  s_waitcnt lgkmcnt(6)
  v_mfma_f32_16x16x32_bf16 v[24:27], v[48:51], v[88:91], v[24:27]
  s_waitcnt lgkmcnt(3)
  v_mfma_f32_16x16x32_bf16 v[20:23], v[48:51], v[84:87], v[20:23]
  s_waitcnt lgkmcnt(0)
  v_mfma_f32_16x16x32_bf16 v[16:19], v[48:51], v[80:83], v[16:19]
  ds_read2_b32 v[48:49], v4 offset0:48 offset1:49
  ds_read2_b32 v[50:51], v4 offset0:50 offset1:51
  ds_read_b128 v[108:111], v12 offset:192
  v_mfma_f32_16x16x32_bf16 v[44:47], v[52:55], v[104:107], v[44:47]
  v_mfma_f32_16x16x32_bf16 v[40:43], v[52:55], v[100:103], v[40:43]
  v_mfma_f32_16x16x32_bf16 v[36:39], v[52:55], v[96:99], v[36:39]
  v_mfma_f32_16x16x32_bf16 v[32:35], v[52:55], v[92:95], v[32:35]
  v_mfma_f32_16x16x32_bf16 v[28:31], v[52:55], v[88:91], v[28:31]
  v_mfma_f32_16x16x32_bf16 v[24:27], v[52:55], v[84:87], v[24:27]
  v_mfma_f32_16x16x32_bf16 v[20:23], v[52:55], v[80:83], v[20:23]
  ds_read2_b32 v[52:53], v5 offset0:48 offset1:49
  ds_read2_b32 v[54:55], v5 offset0:50 offset1:51
  ds_read_b128 v[104:107], v12 offset:704
  v_mfma_f32_16x16x32_bf16 v[44:47], v[56:59], v[100:103], v[44:47]
  v_mfma_f32_16x16x32_bf16 v[40:43], v[56:59], v[96:99], v[40:43]
  v_mfma_f32_16x16x32_bf16 v[36:39], v[56:59], v[92:95], v[36:39]
  v_mfma_f32_16x16x32_bf16 v[32:35], v[56:59], v[88:91], v[32:35]
  v_mfma_f32_16x16x32_bf16 v[28:31], v[56:59], v[84:87], v[28:31]
  v_mfma_f32_16x16x32_bf16 v[24:27], v[56:59], v[80:83], v[24:27]
  ds_read2_b32 v[56:57], v6 offset0:48 offset1:49
  ds_read2_b32 v[58:59], v6 offset0:50 offset1:51
  ds_read_b128 v[100:103], v12 offset:1216
  v_mfma_f32_16x16x32_bf16 v[44:47], v[60:63], v[96:99], v[44:47]
  v_mfma_f32_16x16x32_bf16 v[40:43], v[60:63], v[92:95], v[40:43]
  v_mfma_f32_16x16x32_bf16 v[36:39], v[60:63], v[88:91], v[36:39]
  v_mfma_f32_16x16x32_bf16 v[32:35], v[60:63], v[84:87], v[32:35]
  v_mfma_f32_16x16x32_bf16 v[28:31], v[60:63], v[80:83], v[28:31]
  ds_read2_b32 v[60:61], v7 offset0:48 offset1:49
  ds_read2_b32 v[62:63], v7 offset0:50 offset1:51
  ds_read_b128 v[96:99], v12 offset:1728
  v_mfma_f32_16x16x32_bf16 v[44:47], v[64:67], v[92:95], v[44:47]
  v_mfma_f32_16x16x32_bf16 v[40:43], v[64:67], v[88:91], v[40:43]
  v_mfma_f32_16x16x32_bf16 v[36:39], v[64:67], v[84:87], v[36:39]
  v_mfma_f32_16x16x32_bf16 v[32:35], v[64:67], v[80:83], v[32:35]
  ds_read2_b32 v[64:65], v8 offset0:48 offset1:49
  ds_read2_b32 v[66:67], v8 offset0:50 offset1:51
  ds_read_b128 v[92:95], v12 offset:2240
  v_mfma_f32_16x16x32_bf16 v[44:47], v[68:71], v[88:91], v[44:47]
  v_mfma_f32_16x16x32_bf16 v[40:43], v[68:71], v[84:87], v[40:43]
  v_mfma_f32_16x16x32_bf16 v[36:39], v[68:71], v[80:83], v[36:39]
  ds_read2_b32 v[68:69], v9 offset0:48 offset1:49
  ds_read2_b32 v[70:71], v9 offset0:50 offset1:51
  ds_read_b128 v[88:91], v12 offset:2752
  v_mfma_f32_16x16x32_bf16 v[44:47], v[72:75], v[84:87], v[44:47]
  v_mfma_f32_16x16x32_bf16 v[40:43], v[72:75], v[80:83], v[40:43]
  ds_read2_b32 v[72:73], v10 offset0:48 offset1:49
  ds_read2_b32 v[74:75], v10 offset0:50 offset1:51
  ds_read_b128 v[84:87], v12 offset:3264
  v_mfma_f32_16x16x32_bf16 v[44:47], v[76:79], v[80:83], v[44:47]
  ds_read2_b32 v[76:77], v11 offset0:48 offset1:49
  ds_read2_b32 v[78:79], v11 offset0:50 offset1:51
  ds_read_b128 v[80:83], v12 offset:3776
  s_waitcnt lgkmcnt(15)
  v_mfma_f32_16x16x32_bf16 v[44:47], v[48:51], v[108:111], v[44:47]
  v_mfma_f32_16x16x32_bf16 v[40:43], v[48:51], v[104:107], v[40:43]
  v_mfma_f32_16x16x32_bf16 v[36:39], v[48:51], v[100:103], v[36:39]
  s_waitcnt lgkmcnt(12)
  v_mfma_f32_16x16x32_bf16 v[32:35], v[48:51], v[96:99], v[32:35]
  s_waitcnt lgkmcnt(9)
  v_mfma_f32_16x16x32_bf16 v[28:31], v[48:51], v[92:95], v[28:31]
  s_waitcnt lgkmcnt(6)
  v_mfma_f32_16x16x32_bf16 v[24:27], v[48:51], v[88:91], v[24:27]
  s_waitcnt lgkmcnt(3)
  v_mfma_f32_16x16x32_bf16 v[20:23], v[48:51], v[84:87], v[20:23]
  s_waitcnt lgkmcnt(0)
  v_mfma_f32_16x16x32_bf16 v[16:19], v[48:51], v[80:83], v[16:19]
  ds_read2_b32 v[48:49], v4 offset0:64 offset1:65
  ds_read2_b32 v[50:51], v4 offset0:66 offset1:67
  ds_read_b128 v[108:111], v12 offset:256
  v_mfma_f32_16x16x32_bf16 v[44:47], v[52:55], v[104:107], v[44:47]
  v_mfma_f32_16x16x32_bf16 v[40:43], v[52:55], v[100:103], v[40:43]
  v_mfma_f32_16x16x32_bf16 v[36:39], v[52:55], v[96:99], v[36:39]
  v_mfma_f32_16x16x32_bf16 v[32:35], v[52:55], v[92:95], v[32:35]
  v_mfma_f32_16x16x32_bf16 v[28:31], v[52:55], v[88:91], v[28:31]
  v_mfma_f32_16x16x32_bf16 v[24:27], v[52:55], v[84:87], v[24:27]
  v_mfma_f32_16x16x32_bf16 v[20:23], v[52:55], v[80:83], v[20:23]
  ds_read2_b32 v[52:53], v5 offset0:64 offset1:65
  ds_read2_b32 v[54:55], v5 offset0:66 offset1:67
  ds_read_b128 v[104:107], v12 offset:768
  v_mfma_f32_16x16x32_bf16 v[44:47], v[56:59], v[100:103], v[44:47]
  v_mfma_f32_16x16x32_bf16 v[40:43], v[56:59], v[96:99], v[40:43]
  v_mfma_f32_16x16x32_bf16 v[36:39], v[56:59], v[92:95], v[36:39]
  v_mfma_f32_16x16x32_bf16 v[32:35], v[56:59], v[88:91], v[32:35]
  v_mfma_f32_16x16x32_bf16 v[28:31], v[56:59], v[84:87], v[28:31]
  v_mfma_f32_16x16x32_bf16 v[24:27], v[56:59], v[80:83], v[24:27]
  ds_read2_b32 v[56:57], v6 offset0:64 offset1:65
  ds_read2_b32 v[58:59], v6 offset0:66 offset1:67
  ds_read_b128 v[100:103], v12 offset:1280
  v_mfma_f32_16x16x32_bf16 v[44:47], v[60:63], v[96:99], v[44:47]
  v_mfma_f32_16x16x32_bf16 v[40:43], v[60:63], v[92:95], v[40:43]
  v_mfma_f32_16x16x32_bf16 v[36:39], v[60:63], v[88:91], v[36:39]
  v_mfma_f32_16x16x32_bf16 v[32:35], v[60:63], v[84:87], v[32:35]
  v_mfma_f32_16x16x32_bf16 v[28:31], v[60:63], v[80:83], v[28:31]
  ds_read2_b32 v[60:61], v7 offset0:64 offset1:65
  ds_read2_b32 v[62:63], v7 offset0:66 offset1:67
  ds_read_b128 v[96:99], v12 offset:1792
  v_mfma_f32_16x16x32_bf16 v[44:47], v[64:67], v[92:95], v[44:47]
  v_mfma_f32_16x16x32_bf16 v[40:43], v[64:67], v[88:91], v[40:43]
  v_mfma_f32_16x16x32_bf16 v[36:39], v[64:67], v[84:87], v[36:39]
  v_mfma_f32_16x16x32_bf16 v[32:35], v[64:67], v[80:83], v[32:35]
  ds_read2_b32 v[64:65], v8 offset0:64 offset1:65
  ds_read2_b32 v[66:67], v8 offset0:66 offset1:67
  ds_read_b128 v[92:95], v12 offset:2304
  v_mfma_f32_16x16x32_bf16 v[44:47], v[68:71], v[88:91], v[44:47]
  v_mfma_f32_16x16x32_bf16 v[40:43], v[68:71], v[84:87], v[40:43]
  v_mfma_f32_16x16x32_bf16 v[36:39], v[68:71], v[80:83], v[36:39]
  ds_read2_b32 v[68:69], v9 offset0:64 offset1:65
  ds_read2_b32 v[70:71], v9 offset0:66 offset1:67
  ds_read_b128 v[88:91], v12 offset:2816
  v_mfma_f32_16x16x32_bf16 v[44:47], v[72:75], v[84:87], v[44:47]
  v_mfma_f32_16x16x32_bf16 v[40:43], v[72:75], v[80:83], v[40:43]
  ds_read2_b32 v[72:73], v10 offset0:64 offset1:65
  ds_read2_b32 v[74:75], v10 offset0:66 offset1:67
  ds_read_b128 v[84:87], v12 offset:3328
  v_mfma_f32_16x16x32_bf16 v[44:47], v[76:79], v[80:83], v[44:47]
  ds_read2_b32 v[76:77], v11 offset0:64 offset1:65
  ds_read2_b32 v[78:79], v11 offset0:66 offset1:67
  ds_read_b128 v[80:83], v12 offset:3840
  s_waitcnt lgkmcnt(15)
  v_mfma_f32_16x16x32_bf16 v[44:47], v[48:51], v[108:111], v[44:47]
  v_mfma_f32_16x16x32_bf16 v[40:43], v[48:51], v[104:107], v[40:43]
  v_mfma_f32_16x16x32_bf16 v[36:39], v[48:51], v[100:103], v[36:39]
  s_waitcnt lgkmcnt(12)
  v_mfma_f32_16x16x32_bf16 v[32:35], v[48:51], v[96:99], v[32:35]
  s_waitcnt lgkmcnt(9)
  v_mfma_f32_16x16x32_bf16 v[28:31], v[48:51], v[92:95], v[28:31]
  s_waitcnt lgkmcnt(6)
  v_mfma_f32_16x16x32_bf16 v[24:27], v[48:51], v[88:91], v[24:27]
  s_waitcnt lgkmcnt(3)
  v_mfma_f32_16x16x32_bf16 v[20:23], v[48:51], v[84:87], v[20:23]
  s_waitcnt lgkmcnt(0)
  v_mfma_f32_16x16x32_bf16 v[16:19], v[48:51], v[80:83], v[16:19]
  ds_read2_b32 v[48:49], v4 offset0:80 offset1:81
  ds_read2_b32 v[50:51], v4 offset0:82 offset1:83
  ds_read_b128 v[108:111], v12 offset:320
  v_mfma_f32_16x16x32_bf16 v[44:47], v[52:55], v[104:107], v[44:47]
  v_mfma_f32_16x16x32_bf16 v[40:43], v[52:55], v[100:103], v[40:43]
  v_mfma_f32_16x16x32_bf16 v[36:39], v[52:55], v[96:99], v[36:39]
  v_mfma_f32_16x16x32_bf16 v[32:35], v[52:55], v[92:95], v[32:35]
  v_mfma_f32_16x16x32_bf16 v[28:31], v[52:55], v[88:91], v[28:31]
  v_mfma_f32_16x16x32_bf16 v[24:27], v[52:55], v[84:87], v[24:27]
  v_mfma_f32_16x16x32_bf16 v[20:23], v[52:55], v[80:83], v[20:23]
  ds_read2_b32 v[52:53], v5 offset0:80 offset1:81
  ds_read2_b32 v[54:55], v5 offset0:82 offset1:83
  ds_read_b128 v[104:107], v12 offset:832
  v_mfma_f32_16x16x32_bf16 v[44:47], v[56:59], v[100:103], v[44:47]
  v_mfma_f32_16x16x32_bf16 v[40:43], v[56:59], v[96:99], v[40:43]
  v_mfma_f32_16x16x32_bf16 v[36:39], v[56:59], v[92:95], v[36:39]
  v_mfma_f32_16x16x32_bf16 v[32:35], v[56:59], v[88:91], v[32:35]
  v_mfma_f32_16x16x32_bf16 v[28:31], v[56:59], v[84:87], v[28:31]
  v_mfma_f32_16x16x32_bf16 v[24:27], v[56:59], v[80:83], v[24:27]
  ds_read2_b32 v[56:57], v6 offset0:80 offset1:81
  ds_read2_b32 v[58:59], v6 offset0:82 offset1:83
  ds_read_b128 v[100:103], v12 offset:1344
  v_mfma_f32_16x16x32_bf16 v[44:47], v[60:63], v[96:99], v[44:47]
  v_mfma_f32_16x16x32_bf16 v[40:43], v[60:63], v[92:95], v[40:43]
  v_mfma_f32_16x16x32_bf16 v[36:39], v[60:63], v[88:91], v[36:39]
  v_mfma_f32_16x16x32_bf16 v[32:35], v[60:63], v[84:87], v[32:35]
  v_mfma_f32_16x16x32_bf16 v[28:31], v[60:63], v[80:83], v[28:31]
  ds_read2_b32 v[60:61], v7 offset0:80 offset1:81
  ds_read2_b32 v[62:63], v7 offset0:82 offset1:83
  ds_read_b128 v[96:99], v12 offset:1856
  v_mfma_f32_16x16x32_bf16 v[44:47], v[64:67], v[92:95], v[44:47]
  v_mfma_f32_16x16x32_bf16 v[40:43], v[64:67], v[88:91], v[40:43]
  v_mfma_f32_16x16x32_bf16 v[36:39], v[64:67], v[84:87], v[36:39]
  v_mfma_f32_16x16x32_bf16 v[32:35], v[64:67], v[80:83], v[32:35]
  ds_read2_b32 v[64:65], v8 offset0:80 offset1:81
  ds_read2_b32 v[66:67], v8 offset0:82 offset1:83
  ds_read_b128 v[92:95], v12 offset:2368
  v_mfma_f32_16x16x32_bf16 v[44:47], v[68:71], v[88:91], v[44:47]
  v_mfma_f32_16x16x32_bf16 v[40:43], v[68:71], v[84:87], v[40:43]
  v_mfma_f32_16x16x32_bf16 v[36:39], v[68:71], v[80:83], v[36:39]
  ds_read2_b32 v[68:69], v9 offset0:80 offset1:81
  ds_read2_b32 v[70:71], v9 offset0:82 offset1:83
  ds_read_b128 v[88:91], v12 offset:2880
  v_mfma_f32_16x16x32_bf16 v[44:47], v[72:75], v[84:87], v[44:47]
  v_mfma_f32_16x16x32_bf16 v[40:43], v[72:75], v[80:83], v[40:43]
  ds_read2_b32 v[72:73], v10 offset0:80 offset1:81
  ds_read2_b32 v[74:75], v10 offset0:82 offset1:83
  ds_read_b128 v[84:87], v12 offset:3392
  v_mfma_f32_16x16x32_bf16 v[44:47], v[76:79], v[80:83], v[44:47]
  ds_read2_b32 v[76:77], v11 offset0:80 offset1:81
  ds_read2_b32 v[78:79], v11 offset0:82 offset1:83
  ds_read_b128 v[80:83], v12 offset:3904
  s_waitcnt lgkmcnt(15)
  v_mfma_f32_16x16x32_bf16 v[44:47], v[48:51], v[108:111], v[44:47]
  v_mfma_f32_16x16x32_bf16 v[40:43], v[48:51], v[104:107], v[40:43]
  v_mfma_f32_16x16x32_bf16 v[36:39], v[48:51], v[100:103], v[36:39]
  s_waitcnt lgkmcnt(12)
  v_mfma_f32_16x16x32_bf16 v[32:35], v[48:51], v[96:99], v[32:35]
  s_waitcnt lgkmcnt(9)
  v_mfma_f32_16x16x32_bf16 v[28:31], v[48:51], v[92:95], v[28:31]
  s_waitcnt lgkmcnt(6)
  v_mfma_f32_16x16x32_bf16 v[24:27], v[48:51], v[88:91], v[24:27]
  s_waitcnt lgkmcnt(3)
  v_mfma_f32_16x16x32_bf16 v[20:23], v[48:51], v[84:87], v[20:23]
  s_waitcnt lgkmcnt(0)
  v_mfma_f32_16x16x32_bf16 v[16:19], v[48:51], v[80:83], v[16:19]
  ds_read2_b32 v[48:49], v4 offset0:96 offset1:97
  ds_read2_b32 v[50:51], v4 offset0:98 offset1:99
  ds_read_b128 v[108:111], v12 offset:384
  v_mfma_f32_16x16x32_bf16 v[44:47], v[52:55], v[104:107], v[44:47]
  v_mfma_f32_16x16x32_bf16 v[40:43], v[52:55], v[100:103], v[40:43]
  v_mfma_f32_16x16x32_bf16 v[36:39], v[52:55], v[96:99], v[36:39]
  v_mfma_f32_16x16x32_bf16 v[32:35], v[52:55], v[92:95], v[32:35]
  v_mfma_f32_16x16x32_bf16 v[28:31], v[52:55], v[88:91], v[28:31]
  v_mfma_f32_16x16x32_bf16 v[24:27], v[52:55], v[84:87], v[24:27]
  v_mfma_f32_16x16x32_bf16 v[20:23], v[52:55], v[80:83], v[20:23]
  ds_read2_b32 v[52:53], v5 offset0:96 offset1:97
  ds_read2_b32 v[54:55], v5 offset0:98 offset1:99
  ds_read_b128 v[104:107], v12 offset:896
  v_mfma_f32_16x16x32_bf16 v[44:47], v[56:59], v[100:103], v[44:47]
  v_mfma_f32_16x16x32_bf16 v[40:43], v[56:59], v[96:99], v[40:43]
  v_mfma_f32_16x16x32_bf16 v[36:39], v[56:59], v[92:95], v[36:39]
  v_mfma_f32_16x16x32_bf16 v[32:35], v[56:59], v[88:91], v[32:35]
  v_mfma_f32_16x16x32_bf16 v[28:31], v[56:59], v[84:87], v[28:31]
  v_mfma_f32_16x16x32_bf16 v[24:27], v[56:59], v[80:83], v[24:27]
  ds_read2_b32 v[56:57], v6 offset0:96 offset1:97
  ds_read2_b32 v[58:59], v6 offset0:98 offset1:99
  ds_read_b128 v[100:103], v12 offset:1408
  v_mfma_f32_16x16x32_bf16 v[44:47], v[60:63], v[96:99], v[44:47]
  v_mfma_f32_16x16x32_bf16 v[40:43], v[60:63], v[92:95], v[40:43]
  v_mfma_f32_16x16x32_bf16 v[36:39], v[60:63], v[88:91], v[36:39]
  v_mfma_f32_16x16x32_bf16 v[32:35], v[60:63], v[84:87], v[32:35]
  v_mfma_f32_16x16x32_bf16 v[28:31], v[60:63], v[80:83], v[28:31]
  ds_read2_b32 v[60:61], v7 offset0:96 offset1:97
  ds_read2_b32 v[62:63], v7 offset0:98 offset1:99
  ds_read_b128 v[96:99], v12 offset:1920
  v_mfma_f32_16x16x32_bf16 v[44:47], v[64:67], v[92:95], v[44:47]
  v_mfma_f32_16x16x32_bf16 v[40:43], v[64:67], v[88:91], v[40:43]
  v_mfma_f32_16x16x32_bf16 v[36:39], v[64:67], v[84:87], v[36:39]
  v_mfma_f32_16x16x32_bf16 v[32:35], v[64:67], v[80:83], v[32:35]
  ds_read2_b32 v[64:65], v8 offset0:96 offset1:97
  ds_read2_b32 v[66:67], v8 offset0:98 offset1:99
  ds_read_b128 v[92:95], v12 offset:2432
  v_mfma_f32_16x16x32_bf16 v[44:47], v[68:71], v[88:91], v[44:47]
  v_mfma_f32_16x16x32_bf16 v[40:43], v[68:71], v[84:87], v[40:43]
  v_mfma_f32_16x16x32_bf16 v[36:39], v[68:71], v[80:83], v[36:39]
  ds_read2_b32 v[68:69], v9 offset0:96 offset1:97
  ds_read2_b32 v[70:71], v9 offset0:98 offset1:99
  ds_read_b128 v[88:91], v12 offset:2944
  v_mfma_f32_16x16x32_bf16 v[44:47], v[72:75], v[84:87], v[44:47]
  v_mfma_f32_16x16x32_bf16 v[40:43], v[72:75], v[80:83], v[40:43]
  ds_read2_b32 v[72:73], v10 offset0:96 offset1:97
  ds_read2_b32 v[74:75], v10 offset0:98 offset1:99
  ds_read_b128 v[84:87], v12 offset:3456
  v_mfma_f32_16x16x32_bf16 v[44:47], v[76:79], v[80:83], v[44:47]
  ds_read2_b32 v[76:77], v11 offset0:96 offset1:97
  ds_read2_b32 v[78:79], v11 offset0:98 offset1:99
  ds_read_b128 v[80:83], v12 offset:3968
  s_waitcnt lgkmcnt(15)
  v_mfma_f32_16x16x32_bf16 v[44:47], v[48:51], v[108:111], v[44:47]
  v_mfma_f32_16x16x32_bf16 v[40:43], v[48:51], v[104:107], v[40:43]
  v_mfma_f32_16x16x32_bf16 v[36:39], v[48:51], v[100:103], v[36:39]
  s_waitcnt lgkmcnt(12)
  v_mfma_f32_16x16x32_bf16 v[32:35], v[48:51], v[96:99], v[32:35]
  s_waitcnt lgkmcnt(9)
  v_mfma_f32_16x16x32_bf16 v[28:31], v[48:51], v[92:95], v[28:31]
  s_waitcnt lgkmcnt(6)
  v_mfma_f32_16x16x32_bf16 v[24:27], v[48:51], v[88:91], v[24:27]
  s_waitcnt lgkmcnt(3)
  v_mfma_f32_16x16x32_bf16 v[20:23], v[48:51], v[84:87], v[20:23]
  s_waitcnt lgkmcnt(0)
  v_mfma_f32_16x16x32_bf16 v[16:19], v[48:51], v[80:83], v[16:19]
  ds_read2_b32 v[48:49], v4 offset0:112 offset1:113
  ds_read2_b32 v[50:51], v4 offset0:114 offset1:115
  ds_read_b128 v[108:111], v12 offset:448
  v_mfma_f32_16x16x32_bf16 v[44:47], v[52:55], v[104:107], v[44:47]
  v_mfma_f32_16x16x32_bf16 v[40:43], v[52:55], v[100:103], v[40:43]
  v_mfma_f32_16x16x32_bf16 v[36:39], v[52:55], v[96:99], v[36:39]
  v_mfma_f32_16x16x32_bf16 v[32:35], v[52:55], v[92:95], v[32:35]
  v_mfma_f32_16x16x32_bf16 v[28:31], v[52:55], v[88:91], v[28:31]
  v_mfma_f32_16x16x32_bf16 v[24:27], v[52:55], v[84:87], v[24:27]
  v_mfma_f32_16x16x32_bf16 v[20:23], v[52:55], v[80:83], v[20:23]
  ds_read2_b32 v[52:53], v5 offset0:112 offset1:113
  ds_read2_b32 v[54:55], v5 offset0:114 offset1:115
  ds_read_b128 v[104:107], v12 offset:960
  v_mfma_f32_16x16x32_bf16 v[44:47], v[56:59], v[100:103], v[44:47]
  v_mfma_f32_16x16x32_bf16 v[40:43], v[56:59], v[96:99], v[40:43]
  v_mfma_f32_16x16x32_bf16 v[36:39], v[56:59], v[92:95], v[36:39]
  v_mfma_f32_16x16x32_bf16 v[32:35], v[56:59], v[88:91], v[32:35]
  v_mfma_f32_16x16x32_bf16 v[28:31], v[56:59], v[84:87], v[28:31]
  v_mfma_f32_16x16x32_bf16 v[24:27], v[56:59], v[80:83], v[24:27]
  ds_read2_b32 v[56:57], v6 offset0:112 offset1:113
  ds_read2_b32 v[58:59], v6 offset0:114 offset1:115
  ds_read_b128 v[100:103], v12 offset:1472
  v_mfma_f32_16x16x32_bf16 v[44:47], v[60:63], v[96:99], v[44:47]
  v_mfma_f32_16x16x32_bf16 v[40:43], v[60:63], v[92:95], v[40:43]
  v_mfma_f32_16x16x32_bf16 v[36:39], v[60:63], v[88:91], v[36:39]
  v_mfma_f32_16x16x32_bf16 v[32:35], v[60:63], v[84:87], v[32:35]
  v_mfma_f32_16x16x32_bf16 v[28:31], v[60:63], v[80:83], v[28:31]
  ds_read2_b32 v[60:61], v7 offset0:112 offset1:113
  ds_read2_b32 v[62:63], v7 offset0:114 offset1:115
  ds_read_b128 v[96:99], v12 offset:1984
  v_mfma_f32_16x16x32_bf16 v[44:47], v[64:67], v[92:95], v[44:47]
  v_mfma_f32_16x16x32_bf16 v[40:43], v[64:67], v[88:91], v[40:43]
  v_mfma_f32_16x16x32_bf16 v[36:39], v[64:67], v[84:87], v[36:39]
  v_mfma_f32_16x16x32_bf16 v[32:35], v[64:67], v[80:83], v[32:35]
  ds_read2_b32 v[64:65], v8 offset0:112 offset1:113
  ds_read2_b32 v[66:67], v8 offset0:114 offset1:115
  ds_read_b128 v[92:95], v12 offset:2496
  v_mfma_f32_16x16x32_bf16 v[44:47], v[68:71], v[88:91], v[44:47]
  v_mfma_f32_16x16x32_bf16 v[40:43], v[68:71], v[84:87], v[40:43]
  v_mfma_f32_16x16x32_bf16 v[36:39], v[68:71], v[80:83], v[36:39]
  ds_read2_b32 v[68:69], v9 offset0:112 offset1:113
  ds_read2_b32 v[70:71], v9 offset0:114 offset1:115
  ds_read_b128 v[88:91], v12 offset:3008
  v_mfma_f32_16x16x32_bf16 v[44:47], v[72:75], v[84:87], v[44:47]
  v_mfma_f32_16x16x32_bf16 v[40:43], v[72:75], v[80:83], v[40:43]
  ds_read2_b32 v[72:73], v10 offset0:112 offset1:113
  ds_read2_b32 v[74:75], v10 offset0:114 offset1:115
  ds_read_b128 v[84:87], v12 offset:3520
  v_mfma_f32_16x16x32_bf16 v[44:47], v[76:79], v[80:83], v[44:47]
  ds_read2_b32 v[76:77], v11 offset0:112 offset1:113
  ds_read2_b32 v[78:79], v11 offset0:114 offset1:115
  ds_read_b128 v[80:83], v12 offset:4032
  s_waitcnt lgkmcnt(15)
  v_mfma_f32_16x16x32_bf16 v[44:47], v[48:51], v[108:111], v[44:47]
  v_mfma_f32_16x16x32_bf16 v[40:43], v[48:51], v[104:107], v[40:43]
  v_mfma_f32_16x16x32_bf16 v[36:39], v[48:51], v[100:103], v[36:39]
  s_waitcnt lgkmcnt(12)
  v_mfma_f32_16x16x32_bf16 v[32:35], v[48:51], v[96:99], v[32:35]
  s_waitcnt lgkmcnt(9)
  v_mfma_f32_16x16x32_bf16 v[28:31], v[48:51], v[92:95], v[28:31]
  s_waitcnt lgkmcnt(6)
  v_mfma_f32_16x16x32_bf16 v[24:27], v[48:51], v[88:91], v[24:27]
  s_waitcnt lgkmcnt(3)
  v_mfma_f32_16x16x32_bf16 v[20:23], v[48:51], v[84:87], v[20:23]
  s_waitcnt lgkmcnt(0)
  v_mfma_f32_16x16x32_bf16 v[16:19], v[48:51], v[80:83], v[16:19]
  v_mfma_f32_16x16x32_bf16 v[44:47], v[52:55], v[104:107], v[44:47]
  v_mfma_f32_16x16x32_bf16 v[40:43], v[52:55], v[100:103], v[40:43]
  v_mfma_f32_16x16x32_bf16 v[36:39], v[52:55], v[96:99], v[36:39]
  v_mfma_f32_16x16x32_bf16 v[32:35], v[52:55], v[92:95], v[32:35]
  v_mfma_f32_16x16x32_bf16 v[28:31], v[52:55], v[88:91], v[28:31]
  v_mfma_f32_16x16x32_bf16 v[24:27], v[52:55], v[84:87], v[24:27]
  v_mfma_f32_16x16x32_bf16 v[20:23], v[52:55], v[80:83], v[20:23]
  v_mfma_f32_16x16x32_bf16 v[44:47], v[56:59], v[100:103], v[44:47]
  v_mfma_f32_16x16x32_bf16 v[40:43], v[56:59], v[96:99], v[40:43]
  v_mfma_f32_16x16x32_bf16 v[36:39], v[56:59], v[92:95], v[36:39]
  v_mfma_f32_16x16x32_bf16 v[32:35], v[56:59], v[88:91], v[32:35]
  v_mfma_f32_16x16x32_bf16 v[28:31], v[56:59], v[84:87], v[28:31]
  v_mfma_f32_16x16x32_bf16 v[24:27], v[56:59], v[80:83], v[24:27]
  v_mfma_f32_16x16x32_bf16 v[44:47], v[60:63], v[96:99], v[44:47]
  v_mfma_f32_16x16x32_bf16 v[40:43], v[60:63], v[92:95], v[40:43]
  v_mfma_f32_16x16x32_bf16 v[36:39], v[60:63], v[88:91], v[36:39]
  v_mfma_f32_16x16x32_bf16 v[32:35], v[60:63], v[84:87], v[32:35]
  v_mfma_f32_16x16x32_bf16 v[28:31], v[60:63], v[80:83], v[28:31]
  v_mfma_f32_16x16x32_bf16 v[44:47], v[64:67], v[92:95], v[44:47]
  v_mfma_f32_16x16x32_bf16 v[40:43], v[64:67], v[88:91], v[40:43]
  v_mfma_f32_16x16x32_bf16 v[36:39], v[64:67], v[84:87], v[36:39]
  v_mfma_f32_16x16x32_bf16 v[32:35], v[64:67], v[80:83], v[32:35]
  v_mfma_f32_16x16x32_bf16 v[44:47], v[68:71], v[88:91], v[44:47]
  v_mfma_f32_16x16x32_bf16 v[40:43], v[68:71], v[84:87], v[40:43]
  v_mfma_f32_16x16x32_bf16 v[36:39], v[68:71], v[80:83], v[36:39]
  v_mfma_f32_16x16x32_bf16 v[44:47], v[72:75], v[84:87], v[44:47]
  v_mfma_f32_16x16x32_bf16 v[40:43], v[72:75], v[80:83], v[40:43]
  v_mfma_f32_16x16x32_bf16 v[44:47], v[76:79], v[80:83], v[44:47]
  s_setprio 0
  s_nop 7
  s_waitcnt lgkmcnt(0)
  v_mov_b32 v13, 161876
  v_mov_b32 v14, 1
  s_mov_b64 exec, 1
  ds_add_u32 v13, v14
  s_mov_b64 exec, -1
  v_lshlrev_b32 v13, 5, v2
  v_lshl_add_u32 v13, v3, 3, v13
  s_lshl_b32 s60, s67, 12
  s_add_u32 s60, s60, 5454848
  v_cvt_pk_bf16_f32 v16, v16, v17
  v_cvt_pk_bf16_f32 v17, v18, v19
  buffer_store_dwordx2 v[16:17], v13, s[16:19], s60 offen offset:0 sc1
  v_cvt_pk_bf16_f32 v20, v20, v21
  v_cvt_pk_bf16_f32 v21, v22, v23
  buffer_store_dwordx2 v[20:21], v13, s[16:19], s60 offen offset:512 sc1
  v_cvt_pk_bf16_f32 v24, v24, v25
  v_cvt_pk_bf16_f32 v25, v26, v27
  buffer_store_dwordx2 v[24:25], v13, s[16:19], s60 offen offset:1024 sc1
  v_cvt_pk_bf16_f32 v28, v28, v29
  v_cvt_pk_bf16_f32 v29, v30, v31
  buffer_store_dwordx2 v[28:29], v13, s[16:19], s60 offen offset:1536 sc1
  v_cvt_pk_bf16_f32 v32, v32, v33
  v_cvt_pk_bf16_f32 v33, v34, v35
  buffer_store_dwordx2 v[32:33], v13, s[16:19], s60 offen offset:2048 sc1
  v_cvt_pk_bf16_f32 v36, v36, v37
  v_cvt_pk_bf16_f32 v37, v38, v39
  buffer_store_dwordx2 v[36:37], v13, s[16:19], s60 offen offset:2560 sc1
  v_cvt_pk_bf16_f32 v40, v40, v41
  v_cvt_pk_bf16_f32 v41, v42, v43
  buffer_store_dwordx2 v[40:41], v13, s[16:19], s60 offen offset:3072 sc1
  v_cvt_pk_bf16_f32 v44, v44, v45
  v_cvt_pk_bf16_f32 v45, v46, v47
  buffer_store_dwordx2 v[44:45], v13, s[16:19], s60 offen offset:3584 sc1
  s_waitcnt vmcnt(0) lgkmcnt(0)
  s_lshl_b32 s64, s57, 7
  s_lshl_b32 s61, s56, 2
  s_add_u32 s64, s64, s61
  s_add_u32 s64, s64, 10240
  v_mov_b32 v13, 161868
  v_mov_b32 v14, 1
  s_mov_b64 exec, 1
  ds_add_rtn_u32 v14, v13, v14
  s_waitcnt lgkmcnt(0)
  v_readfirstlane_b32 s60, v14
  s_mov_b64 exec, -1
  s_nop 3
  s_add_u32 s60, s60, 1
  s_cmp_lg_u32 s60, s68
  s_cbranch_scc1 gated_mix__ssm_conv_h3__grouped_kv_mqa__prompt_kernel_y_nsig
  v_mul_u32_u24 v13, 0, v1
  v_mov_b32 v14, s98
  s_mov_b64 exec, 1
  buffer_store_dword v14, v13, s[16:19], s64 offen sc1
  s_mov_b64 exec, -1
gated_mix__ssm_conv_h3__grouped_kv_mqa__prompt_kernel_y_nsig:
  s_mul_i32 s60, s57, 160
  v_add_u32 v13, 0, v1
  v_mul_u32_u24 v14, 0xAAAB, v13
  v_lshrrev_b32 v14, 19, v14
  v_mul_u32_u24 v15, 12, v14
  v_sub_u32 v15, v13, v15
  v_lshrrev_b32 v13, 3, v14
  v_lshlrev_b32 v13, 1, v13
  v_sub_u32 v15, v15, v13
  v_lshlrev_b32 v15, 4, v15
  v_mul_u32_u24 v14, 1280, v14
  v_add_u32 v14, v14, v15
  v_add_u32 v5, s60, v14
  v_add_u32 v13, 64, v1
  v_mul_u32_u24 v14, 0xAAAB, v13
  v_lshrrev_b32 v14, 19, v14
  v_mul_u32_u24 v15, 12, v14
  v_sub_u32 v15, v13, v15
  v_lshrrev_b32 v13, 3, v14
  v_lshlrev_b32 v13, 1, v13
  v_sub_u32 v15, v15, v13
  v_lshlrev_b32 v15, 4, v15
  v_mul_u32_u24 v14, 1280, v14
  v_add_u32 v14, v14, v15
  v_add_u32 v6, s60, v14
  v_add_u32 v13, 128, v1
  v_mul_u32_u24 v14, 0xAAAB, v13
  v_lshrrev_b32 v14, 19, v14
  v_mul_u32_u24 v15, 12, v14
  v_sub_u32 v15, v13, v15
  v_lshrrev_b32 v13, 3, v14
  v_lshlrev_b32 v13, 1, v13
  v_sub_u32 v15, v15, v13
  v_lshlrev_b32 v15, 4, v15
  v_mul_u32_u24 v14, 1280, v14
  v_add_u32 v14, v14, v15
  v_add_u32 v7, s60, v14
  v_mov_b32 v13, 161876
  s_mov_b32 s63, 0
gated_mix__ssm_conv_h3__grouped_kv_mqa__prompt_kernel_acf:
  ds_read_b32 v14, v13
  s_waitcnt lgkmcnt(0)
  v_readfirstlane_b32 s69, v14
  s_nop 3
  s_cmp_ge_u32 s69, s68
  s_cbranch_scc1 gated_mix__ssm_conv_h3__grouped_kv_mqa__prompt_kernel_acf_ok
  s_add_u32 s63, s63, 1
  s_cmp_gt_u32 s63, 1000000
  s_cbranch_scc1 gated_mix__ssm_conv_h3__grouped_kv_mqa__prompt_kernel_exit
  s_branch gated_mix__ssm_conv_h3__grouped_kv_mqa__prompt_kernel_acf
gated_mix__ssm_conv_h3__grouped_kv_mqa__prompt_kernel_acf_ok:
  s_mov_b32 s62, s66
gated_mix__ssm_conv_h3__grouped_kv_mqa__prompt_kernel_aw1:
  s_mul_i32 s60, s62, 20480
  s_mul_i32 s61, s62, 3072
  s_mov_b32 m0, s61
  s_nop 0
  buffer_load_dwordx4 v5, s[36:39], s60 offen lds
  s_add_u32 m0, s61, 1024
  s_nop 0
  buffer_load_dwordx4 v6, s[36:39], s60 offen lds
  s_add_u32 m0, s61, 2048
  s_nop 0
  buffer_load_dwordx4 v7, s[36:39], s60 offen lds
  s_add_u32 s62, s62, s68
  s_cmp_lt_u32 s62, 14
  s_cbranch_scc1 gated_mix__ssm_conv_h3__grouped_kv_mqa__prompt_kernel_aw1
  v_mov_b32 v13, 161952
  s_mov_b32 s63, 0
gated_mix__ssm_conv_h3__grouped_kv_mqa__prompt_kernel_aend:
  ds_read_b32 v14, v13
  s_waitcnt lgkmcnt(0)
  v_readfirstlane_b32 s69, v14
  s_nop 3
  s_cmp_ge_u32 s69, 8
  s_cbranch_scc1 gated_mix__ssm_conv_h3__grouped_kv_mqa__prompt_kernel_aend_ok
  s_add_u32 s63, s63, 1
  s_cmp_gt_u32 s63, 1000000
  s_cbranch_scc1 gated_mix__ssm_conv_h3__grouped_kv_mqa__prompt_kernel_exit
  s_branch gated_mix__ssm_conv_h3__grouped_kv_mqa__prompt_kernel_aend
gated_mix__ssm_conv_h3__grouped_kv_mqa__prompt_kernel_aend_ok:
  s_add_u32 s62, s66, 26
gated_mix__ssm_conv_h3__grouped_kv_mqa__prompt_kernel_aw2:
  s_mul_i32 s60, s62, 20480
  s_mul_i32 s61, s62, 3072
  s_mov_b32 m0, s61
  s_nop 0
  buffer_load_dwordx4 v5, s[36:39], s60 offen lds
  s_add_u32 m0, s61, 1024
  s_nop 0
  buffer_load_dwordx4 v6, s[36:39], s60 offen lds
  s_add_u32 m0, s61, 2048
  s_nop 0
  buffer_load_dwordx4 v7, s[36:39], s60 offen lds
  s_add_u32 s62, s62, s68
  s_cmp_lt_u32 s62, 38
  s_cbranch_scc1 gated_mix__ssm_conv_h3__grouped_kv_mqa__prompt_kernel_aw2
  v_mov_b32 v13, 161956
  s_mov_b32 s63, 0
gated_mix__ssm_conv_h3__grouped_kv_mqa__prompt_kernel_astg:
  ds_read_b32 v14, v13
  s_waitcnt lgkmcnt(0)
  v_readfirstlane_b32 s69, v14
  s_nop 3
  s_cmp_ge_u32 s69, 8
  s_cbranch_scc1 gated_mix__ssm_conv_h3__grouped_kv_mqa__prompt_kernel_astg_ok
  s_add_u32 s63, s63, 1
  s_cmp_gt_u32 s63, 1000000
  s_cbranch_scc1 gated_mix__ssm_conv_h3__grouped_kv_mqa__prompt_kernel_exit
  s_branch gated_mix__ssm_conv_h3__grouped_kv_mqa__prompt_kernel_astg
gated_mix__ssm_conv_h3__grouped_kv_mqa__prompt_kernel_astg_ok:
  s_cmp_ge_u32 s66, 2
  s_cbranch_scc1 gated_mix__ssm_conv_h3__grouped_kv_mqa__prompt_kernel_aw3
  s_add_u32 s62, s66, 38
  s_mul_i32 s60, s62, 20480
  s_mul_i32 s61, s62, 3072
  s_mov_b32 m0, s61
  s_nop 0
  buffer_load_dwordx4 v5, s[36:39], s60 offen lds
  s_add_u32 m0, s61, 1024
  s_nop 0
  buffer_load_dwordx4 v6, s[36:39], s60 offen lds
  s_add_u32 m0, s61, 2048
  s_nop 0
  buffer_load_dwordx4 v7, s[36:39], s60 offen lds
gated_mix__ssm_conv_h3__grouped_kv_mqa__prompt_kernel_aw3:
  s_waitcnt vmcnt(0)
  v_mov_b32 v13, 162080
  v_mov_b32 v14, 1
  s_mov_b64 exec, 1
  ds_add_u32 v13, v14
  s_mov_b64 exec, -1
  s_waitcnt lgkmcnt(0)
  s_branch gated_mix__ssm_conv_h3__grouped_kv_mqa__prompt_kernel_exit
gated_mix__ssm_conv_h3__grouped_kv_mqa__prompt_kernel_loader:
  s_setprio 3
  v_mov_b32 v4, 161856
  v_lshl_add_u32 v4, v1, 2, v4
  v_mov_b32 v12, 0
  ds_write_b32 v4, v12
  s_waitcnt lgkmcnt(0)
  s_load_dword s98, s[16:17], 0
  s_cmp_lt_u32 s57, 4
  s_cselect_b32 s12, s80, s82
  s_cselect_b32 s13, s81, s83
  v_lshlrev_b32 v13, 4, v1
  s_cmp_lg_u32 s58, 8
  s_cbranch_scc1 gated_mix__ssm_conv_h3__grouped_kv_mqa__prompt_kernel_nok24_1
  s_mov_b32 s61, 24576
  s_mov_b32 m0, 155648
  s_nop 0
  buffer_load_dwordx4 v13, s[12:15], s61 offen lds
gated_mix__ssm_conv_h3__grouped_kv_mqa__prompt_kernel_nok24_1:
  s_sub_u32 s60, s58, 8
  s_lshl_b32 s60, s60, 10
  s_add_u32 s61, s60, 0
  s_add_u32 m0, s61, 131072
  s_nop 0
  buffer_load_dwordx4 v13, s[12:15], s61 offen lds
  s_add_u32 s61, s60, 4096
  s_add_u32 m0, s61, 131072
  s_nop 0
  buffer_load_dwordx4 v13, s[12:15], s61 offen lds
  s_add_u32 s61, s60, 8192
  s_add_u32 m0, s61, 131072
  s_nop 0
  buffer_load_dwordx4 v13, s[12:15], s61 offen lds
  s_add_u32 s61, s60, 12288
  s_add_u32 m0, s61, 131072
  s_nop 0
  buffer_load_dwordx4 v13, s[12:15], s61 offen lds
  s_add_u32 s61, s60, 16384
  s_add_u32 m0, s61, 131072
  s_nop 0
  buffer_load_dwordx4 v13, s[12:15], s61 offen lds
  s_add_u32 s61, s60, 20480
  s_add_u32 m0, s61, 131072
  s_nop 0
  buffer_load_dwordx4 v13, s[12:15], s61 offen lds
  v_and_b32 v2, 15, v1
  v_bfe_u32 v3, v1, 4, 2
  s_and_b32 s59, s57, 3
  v_lshlrev_b32 v9, 4, v1
  s_waitcnt lgkmcnt(0)
  s_add_u32 s98, s98, 1
  s_barrier
  v_lshrrev_b32 v13, 3, v2
  s_lshl_b32 s60, s59, 1
  v_add_u32 v13, s60, v13
  v_mul_u32_u24 v13, 10240, v13
  v_and_b32 v14, 7, v2
  v_lshl_add_u32 v13, v14, 7, v13
  v_bfe_u32 v14, v2, 1, 3
  v_xor_b32 v15, v3, v14
  v_lshl_add_u32 v56, v15, 4, v13
  v_add_u32 v15, 4, v3
  v_xor_b32 v15, v15, v14
  v_lshl_add_u32 v57, v15, 4, v13
  s_waitcnt vmcnt(0)
  v_mov_b32 v10, 162048
  v_mov_b32 v11, 1
  s_mov_b64 exec, 1
  ds_add_u32 v10, v11
  s_mov_b64 exec, -1
  s_lshl_b32 s64, s59, 2
  s_add_u32 s64, s64, 161984
  v_mov_b32 v10, s64
  s_mov_b32 s63, 0
gated_mix__ssm_conv_h3__grouped_kv_mqa__prompt_kernel_lxsp:
  ds_read_b32 v11, v10
  s_waitcnt lgkmcnt(0)
  v_readfirstlane_b32 s69, v11
  s_nop 3
  s_cmp_ge_u32 s69, 2
  s_cbranch_scc1 gated_mix__ssm_conv_h3__grouped_kv_mqa__prompt_kernel_lxsp_ok
  s_add_u32 s63, s63, 1
  s_cmp_gt_u32 s63, 1000000
  s_cbranch_scc1 gated_mix__ssm_conv_h3__grouped_kv_mqa__prompt_kernel_exit
  s_branch gated_mix__ssm_conv_h3__grouped_kv_mqa__prompt_kernel_lxsp
gated_mix__ssm_conv_h3__grouped_kv_mqa__prompt_kernel_lxsp_ok:
  ds_read_b128 v[64:67], v56 offset:0
  ds_read_b128 v[68:71], v57 offset:0
  ds_read_b128 v[72:75], v56 offset:1024
  ds_read_b128 v[76:79], v57 offset:1024
  ds_read_b128 v[80:83], v56 offset:2048
  ds_read_b128 v[84:87], v57 offset:2048
  ds_read_b128 v[88:91], v56 offset:3072
  ds_read_b128 v[92:95], v57 offset:3072
  ds_read_b128 v[96:99], v56 offset:4096
  ds_read_b128 v[100:103], v57 offset:4096
  s_waitcnt lgkmcnt(0)
  s_add_u32 s64, s64, 16
  v_mov_b32 v10, s64
  v_mov_b32 v11, 1
  s_mov_b64 exec, 1
  ds_add_u32 v10, v11
  s_mov_b64 exec, -1
  v_mov_b32 v10, 162048
  s_mov_b32 s63, 0
gated_mix__ssm_conv_h3__grouped_kv_mqa__prompt_kernel_lkvin:
  ds_read_b32 v11, v10
  s_waitcnt lgkmcnt(0)
  v_readfirstlane_b32 s69, v11
  s_nop 3
  s_cmp_ge_u32 s69, 4
  s_cbranch_scc1 gated_mix__ssm_conv_h3__grouped_kv_mqa__prompt_kernel_lkvin_ok
  s_add_u32 s63, s63, 1
  s_cmp_gt_u32 s63, 1000000
  s_cbranch_scc1 gated_mix__ssm_conv_h3__grouped_kv_mqa__prompt_kernel_exit
  s_branch gated_mix__ssm_conv_h3__grouped_kv_mqa__prompt_kernel_lkvin
gated_mix__ssm_conv_h3__grouped_kv_mqa__prompt_kernel_lkvin_ok:
  v_lshrrev_b32 v13, 2, v2
  v_lshl_add_u32 v13, v3, 3, v13
  v_mul_u32_u24 v58, 40, v13
  v_and_b32 v15, 3, v1
  v_lshl_add_u32 v10, v15, 3, v58
  v_add_u32 v10, 131072, v10
  v_add_u32 v11, 131104, v58
  v_lshlrev_b32 v13, 3, v13
  v_add_u32 v13, 156736, v13
  v_cmp_eq_u32 vcc, 0, v15
  v_mov_b32 v12, 256
  v_mov_b32 v58, 1280
  v_cndmask_b32 v11, v13, v11, vcc
  v_cndmask_b32 v12, v12, v58, vcc
  v_mov_b32 v13, 32
  v_mov_b32 v58, 160
  v_cndmask_b32 v13, v13, v58, vcc
  v_add_u32 v14, v11, v13
  v_mov_b32 v152, 0
  v_mov_b32 v153, 0
  v_mov_b32 v154, 0
  v_mov_b32 v155, 0
  v_mov_b32 v156, 0
  v_mov_b32 v157, 0
  v_mov_b32 v158, 0
  v_mov_b32 v159, 0
  s_cmp_ge_u32 s57, 4
  s_cbranch_scc1 gated_mix__ssm_conv_h3__grouped_kv_mqa__prompt_kernel_kvVL
  ds_read_b64_tr_b16 v[16:17], v10 offset:0
  ds_read_b64_tr_b16 v[18:19], v10 offset:160
  ds_read_b64_tr_b16 v[20:21], v11
  ds_read_b64_tr_b16 v[22:23], v14
  v_add_u32 v11, v11, v12
  v_add_u32 v14, v14, v12
  ds_read_b64_tr_b16 v[24:25], v10 offset:1280
  ds_read_b64_tr_b16 v[26:27], v10 offset:1440
  ds_read_b64_tr_b16 v[28:29], v11
  ds_read_b64_tr_b16 v[30:31], v14
  v_add_u32 v11, v11, v12
  v_add_u32 v14, v14, v12
  ds_read_b64_tr_b16 v[32:33], v10 offset:2560
  ds_read_b64_tr_b16 v[34:35], v10 offset:2720
  ds_read_b64_tr_b16 v[36:37], v11
  ds_read_b64_tr_b16 v[38:39], v14
  v_add_u32 v11, v11, v12
  v_add_u32 v14, v14, v12
  ds_read_b64_tr_b16 v[40:41], v10 offset:3840
  ds_read_b64_tr_b16 v[42:43], v10 offset:4000
  ds_read_b64_tr_b16 v[44:45], v11
  ds_read_b64_tr_b16 v[46:47], v14
  v_add_u32 v11, v11, v12
  v_add_u32 v14, v14, v12
  s_waitcnt lgkmcnt(12)
  v_mfma_f32_16x16x32_bf16 v[152:155], v[16:19], v[64:67], v[152:155]
  v_mfma_f32_16x16x32_bf16 v[156:159], v[20:23], v[64:67], v[156:159]
  ds_read_b64_tr_b16 v[48:49], v10 offset:5120
  ds_read_b64_tr_b16 v[50:51], v10 offset:5280
  ds_read_b64_tr_b16 v[52:53], v11
  ds_read_b64_tr_b16 v[54:55], v14
  v_add_u32 v11, v11, v12
  v_add_u32 v14, v14, v12
  s_waitcnt lgkmcnt(12)
  v_mfma_f32_16x16x32_bf16 v[152:155], v[24:27], v[68:71], v[152:155]
  v_mfma_f32_16x16x32_bf16 v[156:159], v[28:31], v[68:71], v[156:159]
  ds_read_b64_tr_b16 v[104:105], v10 offset:6400
  ds_read_b64_tr_b16 v[106:107], v10 offset:6560
  ds_read_b64_tr_b16 v[108:109], v11
  ds_read_b64_tr_b16 v[110:111], v14
  v_add_u32 v11, v11, v12
  v_add_u32 v14, v14, v12
  s_waitcnt lgkmcnt(12)
  v_mfma_f32_16x16x32_bf16 v[152:155], v[32:35], v[72:75], v[152:155]
  v_mfma_f32_16x16x32_bf16 v[156:159], v[36:39], v[72:75], v[156:159]
  ds_read_b64_tr_b16 v[112:113], v10 offset:7680
  ds_read_b64_tr_b16 v[114:115], v10 offset:7840
  ds_read_b64_tr_b16 v[116:117], v11
  ds_read_b64_tr_b16 v[118:119], v14
  v_add_u32 v11, v11, v12
  v_add_u32 v14, v14, v12
  s_waitcnt lgkmcnt(12)
  v_mfma_f32_16x16x32_bf16 v[152:155], v[40:43], v[76:79], v[152:155]
  v_mfma_f32_16x16x32_bf16 v[156:159], v[44:47], v[76:79], v[156:159]
  ds_read_b64_tr_b16 v[120:121], v10 offset:8960
  ds_read_b64_tr_b16 v[122:123], v10 offset:9120
  ds_read_b64_tr_b16 v[124:125], v11
  ds_read_b64_tr_b16 v[126:127], v14
  v_add_u32 v11, v11, v12
  v_add_u32 v14, v14, v12
  s_waitcnt lgkmcnt(12)
  v_mfma_f32_16x16x32_bf16 v[152:155], v[48:51], v[80:83], v[152:155]
  v_mfma_f32_16x16x32_bf16 v[156:159], v[52:55], v[80:83], v[156:159]
  ds_read_b64_tr_b16 v[128:129], v10 offset:10240
  ds_read_b64_tr_b16 v[130:131], v10 offset:10400
  ds_read_b64_tr_b16 v[132:133], v11
  ds_read_b64_tr_b16 v[134:135], v14
  v_add_u32 v11, v11, v12
  v_add_u32 v14, v14, v12
  s_waitcnt lgkmcnt(12)
  v_mfma_f32_16x16x32_bf16 v[152:155], v[104:107], v[84:87], v[152:155]
  v_mfma_f32_16x16x32_bf16 v[156:159], v[108:111], v[84:87], v[156:159]
  ds_read_b64_tr_b16 v[136:137], v10 offset:11520
  ds_read_b64_tr_b16 v[138:139], v10 offset:11680
  ds_read_b64_tr_b16 v[140:141], v11
  ds_read_b64_tr_b16 v[142:143], v14
  v_add_u32 v11, v11, v12
  v_add_u32 v14, v14, v12
  s_waitcnt lgkmcnt(12)
  v_mfma_f32_16x16x32_bf16 v[152:155], v[112:115], v[88:91], v[152:155]
  v_mfma_f32_16x16x32_bf16 v[156:159], v[116:119], v[88:91], v[156:159]
  s_waitcnt lgkmcnt(8)
  v_mfma_f32_16x16x32_bf16 v[152:155], v[120:123], v[92:95], v[152:155]
  v_mfma_f32_16x16x32_bf16 v[156:159], v[124:127], v[92:95], v[156:159]
  s_waitcnt lgkmcnt(4)
  v_mfma_f32_16x16x32_bf16 v[152:155], v[128:131], v[96:99], v[152:155]
  v_mfma_f32_16x16x32_bf16 v[156:159], v[132:135], v[96:99], v[156:159]
  s_waitcnt lgkmcnt(0)
  v_mfma_f32_16x16x32_bf16 v[152:155], v[136:139], v[100:103], v[152:155]
  v_mfma_f32_16x16x32_bf16 v[156:159], v[140:143], v[100:103], v[156:159]
  s_branch gated_mix__ssm_conv_h3__grouped_kv_mqa__prompt_kernel_kvEL
gated_mix__ssm_conv_h3__grouped_kv_mqa__prompt_kernel_kvVL:
  ds_read_b64_tr_b16 v[16:17], v10 offset:0
  ds_read_b64_tr_b16 v[18:19], v10 offset:160
  ds_read_b64_tr_b16 v[20:21], v11
  ds_read_b64_tr_b16 v[22:23], v14
  v_add_u32 v11, v11, v12
  v_add_u32 v14, v14, v12
  ds_read_b64_tr_b16 v[24:25], v10 offset:1280
  ds_read_b64_tr_b16 v[26:27], v10 offset:1440
  ds_read_b64_tr_b16 v[28:29], v11
  ds_read_b64_tr_b16 v[30:31], v14
  v_add_u32 v11, v11, v12
  v_add_u32 v14, v14, v12
  ds_read_b64_tr_b16 v[32:33], v10 offset:2560
  ds_read_b64_tr_b16 v[34:35], v10 offset:2720
  ds_read_b64_tr_b16 v[36:37], v11
  ds_read_b64_tr_b16 v[38:39], v14
  v_add_u32 v11, v11, v12
  v_add_u32 v14, v14, v12
  ds_read_b64_tr_b16 v[40:41], v10 offset:3840
  ds_read_b64_tr_b16 v[42:43], v10 offset:4000
  ds_read_b64_tr_b16 v[44:45], v11
  ds_read_b64_tr_b16 v[46:47], v14
  v_add_u32 v11, v11, v12
  v_add_u32 v14, v14, v12
  s_waitcnt lgkmcnt(12)
  v_mfma_f32_16x16x32_bf16 v[152:155], v[64:67], v[16:19], v[152:155]
  v_mfma_f32_16x16x32_bf16 v[156:159], v[64:67], v[20:23], v[156:159]
  ds_read_b64_tr_b16 v[48:49], v10 offset:5120
  ds_read_b64_tr_b16 v[50:51], v10 offset:5280
  ds_read_b64_tr_b16 v[52:53], v11
  ds_read_b64_tr_b16 v[54:55], v14
  v_add_u32 v11, v11, v12
  v_add_u32 v14, v14, v12
  s_waitcnt lgkmcnt(12)
  v_mfma_f32_16x16x32_bf16 v[152:155], v[68:71], v[24:27], v[152:155]
  v_mfma_f32_16x16x32_bf16 v[156:159], v[68:71], v[28:31], v[156:159]
  ds_read_b64_tr_b16 v[104:105], v10 offset:6400
  ds_read_b64_tr_b16 v[106:107], v10 offset:6560
  ds_read_b64_tr_b16 v[108:109], v11
  ds_read_b64_tr_b16 v[110:111], v14
  v_add_u32 v11, v11, v12
  v_add_u32 v14, v14, v12
  s_waitcnt lgkmcnt(12)
  v_mfma_f32_16x16x32_bf16 v[152:155], v[72:75], v[32:35], v[152:155]
  v_mfma_f32_16x16x32_bf16 v[156:159], v[72:75], v[36:39], v[156:159]
  ds_read_b64_tr_b16 v[112:113], v10 offset:7680
  ds_read_b64_tr_b16 v[114:115], v10 offset:7840
  ds_read_b64_tr_b16 v[116:117], v11
  ds_read_b64_tr_b16 v[118:119], v14
  v_add_u32 v11, v11, v12
  v_add_u32 v14, v14, v12
  s_waitcnt lgkmcnt(12)
  v_mfma_f32_16x16x32_bf16 v[152:155], v[76:79], v[40:43], v[152:155]
  v_mfma_f32_16x16x32_bf16 v[156:159], v[76:79], v[44:47], v[156:159]
  ds_read_b64_tr_b16 v[120:121], v10 offset:8960
  ds_read_b64_tr_b16 v[122:123], v10 offset:9120
  ds_read_b64_tr_b16 v[124:125], v11
  ds_read_b64_tr_b16 v[126:127], v14
  v_add_u32 v11, v11, v12
  v_add_u32 v14, v14, v12
  s_waitcnt lgkmcnt(12)
  v_mfma_f32_16x16x32_bf16 v[152:155], v[80:83], v[48:51], v[152:155]
  v_mfma_f32_16x16x32_bf16 v[156:159], v[80:83], v[52:55], v[156:159]
  ds_read_b64_tr_b16 v[128:129], v10 offset:10240
  ds_read_b64_tr_b16 v[130:131], v10 offset:10400
  ds_read_b64_tr_b16 v[132:133], v11
  ds_read_b64_tr_b16 v[134:135], v14
  v_add_u32 v11, v11, v12
  v_add_u32 v14, v14, v12
  s_waitcnt lgkmcnt(12)
  v_mfma_f32_16x16x32_bf16 v[152:155], v[84:87], v[104:107], v[152:155]
  v_mfma_f32_16x16x32_bf16 v[156:159], v[84:87], v[108:111], v[156:159]
  ds_read_b64_tr_b16 v[136:137], v10 offset:11520
  ds_read_b64_tr_b16 v[138:139], v10 offset:11680
  ds_read_b64_tr_b16 v[140:141], v11
  ds_read_b64_tr_b16 v[142:143], v14
  v_add_u32 v11, v11, v12
  v_add_u32 v14, v14, v12
  s_waitcnt lgkmcnt(12)
  v_mfma_f32_16x16x32_bf16 v[152:155], v[88:91], v[112:115], v[152:155]
  v_mfma_f32_16x16x32_bf16 v[156:159], v[88:91], v[116:119], v[156:159]
  s_waitcnt lgkmcnt(8)
  v_mfma_f32_16x16x32_bf16 v[152:155], v[92:95], v[120:123], v[152:155]
  v_mfma_f32_16x16x32_bf16 v[156:159], v[92:95], v[124:127], v[156:159]
  s_waitcnt lgkmcnt(4)
  v_mfma_f32_16x16x32_bf16 v[152:155], v[96:99], v[128:131], v[152:155]
  v_mfma_f32_16x16x32_bf16 v[156:159], v[96:99], v[132:135], v[156:159]
  s_waitcnt lgkmcnt(0)
  v_mfma_f32_16x16x32_bf16 v[152:155], v[100:103], v[136:139], v[152:155]
  v_mfma_f32_16x16x32_bf16 v[156:159], v[100:103], v[140:143], v[156:159]
gated_mix__ssm_conv_h3__grouped_kv_mqa__prompt_kernel_kvEL:
  v_mov_b32 v10, 162072
  s_mov_b32 s63, 0
gated_mix__ssm_conv_h3__grouped_kv_mqa__prompt_kernel_lkvp:
  ds_read_b32 v11, v10
  s_waitcnt lgkmcnt(0)
  v_readfirstlane_b32 s69, v11
  s_nop 3
  s_cmp_ge_u32 s69, 1
  s_cbranch_scc1 gated_mix__ssm_conv_h3__grouped_kv_mqa__prompt_kernel_lkvp_ok
  s_add_u32 s63, s63, 1
  s_cmp_gt_u32 s63, 1000000
  s_cbranch_scc1 gated_mix__ssm_conv_h3__grouped_kv_mqa__prompt_kernel_exit
  s_branch gated_mix__ssm_conv_h3__grouped_kv_mqa__prompt_kernel_lkvp
gated_mix__ssm_conv_h3__grouped_kv_mqa__prompt_kernel_lkvp_ok:
  v_lshlrev_b32 v59, 4, v1
  v_add_u32 v59, 162112, v59
  v_lshl_add_u32 v58, v3, 2, v2
  v_lshlrev_b32 v58, 4, v58
  v_add_u32 v58, 163136, v58
  v_add_u32 v60, 1024, v59
  v_cmp_gt_u32 s[62:63], 4, v2
  s_cmp_lt_u32 s57, 4
  s_nop 2
  s_cselect_b32 s62, -1, s62
  s_cselect_b32 s63, 0, s63
  s_cselect_b64 vcc, -1, 0
  v_cndmask_b32 v58, v58, v60, vcc
  ds_read_b128 v[16:19], v59
  v_mov_b32 v20, 0
  v_mov_b32 v21, 0
  v_mov_b32 v22, 0
  v_mov_b32 v23, 0
  s_mov_b64 exec, s[62:63]
  ds_read_b128 v[20:23], v58
  s_mov_b64 exec, -1
  s_waitcnt lgkmcnt(0)
  v_add_f32 v152, v152, v16
  v_add_f32 v156, v156, v20
  v_add_f32 v153, v153, v17
  v_add_f32 v157, v157, v21
  v_add_f32 v154, v154, v18
  v_add_f32 v158, v158, v22
  v_add_f32 v155, v155, v19
  v_add_f32 v159, v159, v23
  v_mov_b32 v10, 162064
  v_mov_b32 v11, 1
  s_mov_b64 exec, 1
  ds_add_u32 v10, v11
  s_mov_b64 exec, -1
  s_cmp_ge_u32 s57, 4
  s_cbranch_scc1 gated_mix__ssm_conv_h3__grouped_kv_mqa__prompt_kernel_kvV
  s_lshl_b32 s60, s56, 1
  s_bfe_u32 s61, s57, 0x10001
  s_add_u32 s60, s60, s61
  s_mul_i32 s60, s60, 2640
  s_add_u32 s60, s60, 32768
  s_and_b32 s61, s57, 1
  s_lshl_b32 s61, s61, 4
  v_add_u32 v58, s61, v2
  v_lshrrev_b32 v13, 1, v3
  v_lshlrev_b32 v13, 9, v13
  v_lshl_add_u32 v13, v58, 4, v13
  v_and_b32 v15, 1, v3
  v_lshl_add_u32 v13, v15, 3, v13
  v_cvt_pk_bf16_f32 v60, v152, v153
  v_cvt_pk_bf16_f32 v61, v154, v155
  v_cvt_pk_bf16_f32 v62, v156, v157
  v_cvt_pk_bf16_f32 v63, v158, v159
  buffer_store_dwordx2 v[60:61], v13, s[16:19], s60 offen sc1
  v_lshlrev_b32 v15, 3, v58
  v_add_u32 v15, 1024, v15
  v_mov_b32 v58, 1280
  v_cmp_eq_u32 vcc, 1, v3
  v_mov_b32 v59, 0x3f803f80
  v_mov_b32 v13, 0x00003f80
  v_cndmask_b32 v15, v15, v58, vcc
  v_cndmask_b32 v62, v62, v59, vcc
  v_cndmask_b32 v63, v63, v13, vcc
  v_cmp_gt_u32 vcc, 2, v3
  s_nop 3
  s_and_saveexec_b64 s[62:63], vcc
  buffer_store_dwordx2 v[62:63], v15, s[16:19], s60 offen sc1
  s_mov_b64 exec, s[62:63]
  v_cmp_eq_u32 vcc, 0, v3
  v_mul_f32 v58, v152, v152
  v_fmac_f32 v58, v153, v153
  v_fmac_f32 v58, v154, v154
  v_fmac_f32 v58, v155, v155
  v_mul_f32 v59, v156, v156
  v_fmac_f32 v59, v157, v157
  v_fmac_f32 v59, v158, v158
  v_fmac_f32 v59, v159, v159
  v_cndmask_b32 v59, 0, v59, vcc
  v_add_f32 v58, v58, v59
  v_mov_b32 v59, v58
  s_nop 1
  v_permlane16_swap_b32 v58, v59
  v_add_f32 v58, v58, v59
  v_mov_b32 v59, v58
  s_nop 1
  v_permlane32_swap_b32 v58, v59
  v_add_f32 v58, v58, v59
  s_nop 1
  v_max_f32_dpp v58, v58, v58 row_shr:1 row_mask:0xf bank_mask:0xf
  s_nop 1
  v_max_f32_dpp v58, v58, v58 row_shr:2 row_mask:0xf bank_mask:0xf
  s_nop 1
  v_max_f32_dpp v58, v58, v58 row_shr:4 row_mask:0xf bank_mask:0xf
  s_nop 1
  v_max_f32_dpp v58, v58, v58 row_shr:8 row_mask:0xf bank_mask:0xf
  s_lshl_b32 s60, s56, 2
  s_and_b32 s61, s57, 3
  s_add_u32 s60, s60, s61
  s_lshl_b32 s60, s60, 2
  s_add_u32 s60, s60, 202752
  v_mov_b32 v13, 0
  v_cmp_eq_u32 vcc, 15, v1
  s_nop 3
  s_and_saveexec_b64 s[62:63], vcc
  buffer_store_dword v58, v13, s[16:19], s60 offen sc1
  s_mov_b64 exec, s[62:63]
  v_mul_f32 v59, 0xbfb8aa3b, v156
  v_exp_f32 v59, v59
  s_nop 0
  v_add_f32 v59, 1.0, v59
  v_rcp_f32 v59, v59
  s_lshl_b32 s60, s56, 6
  s_lshl_b32 s61, s59, 4
  s_add_u32 s60, s60, s61
  s_lshl_b32 s60, s60, 2
  s_add_u32 s60, s60, 203776
  v_lshlrev_b32 v13, 2, v2
  v_cmp_eq_u32 vcc, 1, v3
  s_nop 3
  s_and_saveexec_b64 s[62:63], vcc
  buffer_store_dword v59, v13, s[16:19], s60 offen sc1
  s_mov_b64 exec, s[62:63]
  s_branch gated_mix__ssm_conv_h3__grouped_kv_mqa__prompt_kernel_kvdone
gated_mix__ssm_conv_h3__grouped_kv_mqa__prompt_kernel_kvV:
  s_lshl_b32 s60, s56, 1
  s_bfe_u32 s61, s57, 0x10001
  s_add_u32 s60, s60, s61
  s_mul_i32 s60, s60, 2640
  s_and_b32 s61, s57, 1
  s_mul_i32 s61, s61, 672
  s_add_u32 s60, s60, s61
  s_add_u32 s60, s60, 34064
  v_and_b32 v13, 1, v3
  v_mul_u32_u24 v13, 336, v13
  v_lshl_add_u32 v13, v2, 4, v13
  v_lshrrev_b32 v58, 1, v3
  v_lshl_add_u32 v13, v58, 3, v13
  v_cvt_pk_bf16_f32 v60, v152, v153
  v_cvt_pk_bf16_f32 v61, v154, v155
  v_cvt_pk_bf16_f32 v62, v156, v157
  v_cvt_pk_bf16_f32 v63, v158, v159
  v_mov_b32 v58, 0x3f803f80
  v_cmp_eq_u32 vcc, 4, v2
  buffer_store_dwordx2 v[60:61], v13, s[16:19], s60 offen sc1
  s_nop 0
  v_cndmask_b32 v62, v62, v58, vcc
  v_cndmask_b32 v63, v63, v58, vcc
  v_cmp_gt_u32 vcc, 5, v2
  s_nop 3
  s_and_saveexec_b64 s[62:63], vcc
  buffer_store_dwordx2 v[62:63], v13, s[16:19], s60 offen offset:256 sc1
  s_mov_b64 exec, s[62:63]
  v_max3_f32 v58, abs(v152), abs(v153), abs(v154)
  v_max_f32 v58, v58, abs(v155)
  v_max3_f32 v59, abs(v156), abs(v157), abs(v158)
  v_max_f32 v59, v59, abs(v159)
  v_cmp_gt_u32 vcc, 4, v2
  s_nop 1
  v_cndmask_b32 v59, 0, v59, vcc
  v_max_f32 v58, v58, v59
  s_nop 1
  v_max_f32_dpp v58, v58, v58 row_shr:1 row_mask:0xf bank_mask:0xf
  s_nop 1
  v_max_f32_dpp v58, v58, v58 row_shr:2 row_mask:0xf bank_mask:0xf
  s_nop 1
  v_max_f32_dpp v58, v58, v58 row_shr:4 row_mask:0xf bank_mask:0xf
  s_nop 1
  v_max_f32_dpp v58, v58, v58 row_shr:8 row_mask:0xf bank_mask:0xf
  s_nop 1
  v_max_f32_dpp v58, v58, v58 row_bcast:15 row_mask:0xa bank_mask:0xf
  s_nop 1
  v_max_f32_dpp v58, v58, v58 row_bcast:31 row_mask:0xc bank_mask:0xf
  s_lshl_b32 s60, s56, 2
  s_and_b32 s61, s57, 3
  s_add_u32 s60, s60, s61
  s_lshl_b32 s60, s60, 2
  s_add_u32 s60, s60, 203264
  v_mov_b32 v13, 0
  s_mov_b32 exec_lo, 0
  s_mov_b32 exec_hi, 0x80000000
  buffer_store_dword v58, v13, s[16:19], s60 offen sc1
  s_mov_b64 exec, -1
gated_mix__ssm_conv_h3__grouped_kv_mqa__prompt_kernel_kvdone:
  s_getreg_b32 s60, hwreg(HW_REG_XCC_ID)
  s_and_b32 s60, s60, 15
  v_mov_b32 v58, s60
  s_lshl_b32 s61, s2, 2
  s_add_u32 s61, s61, 19456
  v_mov_b32 v13, 0
  s_mov_b64 exec, 1
  buffer_store_dword v58, v13, s[16:19], s61 offen sc1
  s_mov_b64 exec, -1
  s_waitcnt vmcnt(0)
  s_and_b32 s64, s2, 7
  s_lshl_b32 s64, s64, 7
  s_lshr_b32 s61, s2, 3
  s_lshl_b32 s61, s61, 2
  s_add_u32 s64, s64, s61
  s_add_u32 s64, s64, 1024
  v_mul_u32_u24 v13, 1024, v1
  v_mov_b32 v15, s98
  s_mov_b64 exec, 255
  buffer_store_dword v15, v13, s[16:19], s64 offen sc1
  s_mov_b64 exec, -1
  s_mul_i32 s60, s57, 160
  v_add_u32 v13, 0, v1
  v_mul_u32_u24 v14, 0xAAAB, v13
  v_lshrrev_b32 v14, 19, v14
  v_mul_u32_u24 v15, 12, v14
  v_sub_u32 v15, v13, v15
  v_lshrrev_b32 v13, 3, v14
  v_lshlrev_b32 v13, 1, v13
  v_sub_u32 v15, v15, v13
  v_lshlrev_b32 v15, 4, v15
  v_mul_u32_u24 v14, 1280, v14
  v_add_u32 v14, v14, v15
  v_add_u32 v5, s60, v14
  v_add_u32 v13, 64, v1
  v_mul_u32_u24 v14, 0xAAAB, v13
  v_lshrrev_b32 v14, 19, v14
  v_mul_u32_u24 v15, 12, v14
  v_sub_u32 v15, v13, v15
  v_lshrrev_b32 v13, 3, v14
  v_lshlrev_b32 v13, 1, v13
  v_sub_u32 v15, v15, v13
  v_lshlrev_b32 v15, 4, v15
  v_mul_u32_u24 v14, 1280, v14
  v_add_u32 v14, v14, v15
  v_add_u32 v6, s60, v14
  v_add_u32 v13, 128, v1
  v_mul_u32_u24 v14, 0xAAAB, v13
  v_lshrrev_b32 v14, 19, v14
  v_mul_u32_u24 v15, 12, v14
  v_sub_u32 v15, v13, v15
  v_lshrrev_b32 v13, 3, v14
  v_lshlrev_b32 v13, 1, v13
  v_sub_u32 v15, v15, v13
  v_lshlrev_b32 v15, 4, v15
  v_mul_u32_u24 v14, 1280, v14
  v_add_u32 v14, v14, v15
  v_add_u32 v7, s60, v14
  v_lshlrev_b32 v9, 4, v1
  s_and_b32 s75, s2, 7
  s_lshr_b32 s79, s2, 3
  s_and_b32 s79, s79, 7
  s_lshl_b32 s79, s79, 10
  s_add_u32 s79, s79, 1024
  v_lshlrev_b32 v10, 2, v1
  s_lshl_b32 s64, s75, 7
  s_add_u32 s64, s64, s79
  s_mov_b32 s63, 0
  s_mov_b64 exec, 0xffffffff
gated_mix__ssm_conv_h3__grouped_kv_mqa__prompt_kernel_pa_again:
  buffer_load_dword v16, v10, s[16:19], s64 offen sc1
  s_waitcnt vmcnt(0)
  v_cmp_ne_u32 vcc, s98, v16
  s_nop 4
  s_cmp_eq_u64 vcc, 0
  s_cbranch_scc1 gated_mix__ssm_conv_h3__grouped_kv_mqa__prompt_kernel_pa_ok
  s_sleep 1
  s_add_u32 s63, s63, 1
  s_cmp_gt_u32 s63, 100000
  s_cbranch_scc1 gated_mix__ssm_conv_h3__grouped_kv_mqa__prompt_kernel_exit
  s_branch gated_mix__ssm_conv_h3__grouped_kv_mqa__prompt_kernel_pa_again
gated_mix__ssm_conv_h3__grouped_kv_mqa__prompt_kernel_pa_ok:
  s_mov_b64 exec, -1
  v_mov_b32 v11, 162052
  s_mov_b32 s63, 0
gated_mix__ssm_conv_h3__grouped_kv_mqa__prompt_kernel_lg1:
  ds_read_b32 v12, v11
  s_waitcnt lgkmcnt(0)
  v_readfirstlane_b32 s69, v12
  s_nop 3
  s_cmp_ge_u32 s69, 8
  s_cbranch_scc1 gated_mix__ssm_conv_h3__grouped_kv_mqa__prompt_kernel_lg1_ok
  s_add_u32 s63, s63, 1
  s_cmp_gt_u32 s63, 1000000
  s_cbranch_scc1 gated_mix__ssm_conv_h3__grouped_kv_mqa__prompt_kernel_exit
  s_branch gated_mix__ssm_conv_h3__grouped_kv_mqa__prompt_kernel_lg1
gated_mix__ssm_conv_h3__grouped_kv_mqa__prompt_kernel_lg1_ok:
  s_mov_b32 s78, 0
  s_mov_b32 s84, 0
  s_mov_b32 s76, 0
  s_mov_b32 s85, 0
  s_mov_b32 s71, 14
gated_mix__ssm_conv_h3__grouped_kv_mqa__prompt_kernel_pass:
  s_mov_b32 s77, 0
  s_mov_b32 s83, 2
gated_mix__ssm_conv_h3__grouped_kv_mqa__prompt_kernel_pl:
  s_cmp_lt_u32 s77, 3
  s_cbranch_scc1 gated_mix__ssm_conv_h3__grouped_kv_mqa__prompt_kernel_pl_nw
  s_sub_u32 s80, s77, 1
  s_lshl_b32 s80, s80, 3
  s_add_u32 s80, s80, s76
  s_mov_b32 s63, 0
  v_mov_b32 v4, 161884
gated_mix__ssm_conv_h3__grouped_kv_mqa__prompt_kernel_pl_wd:
  ds_read_b32 v12, v4
  s_waitcnt lgkmcnt(0)
  v_readfirstlane_b32 s69, v12
  s_nop 3
  s_cmp_ge_u32 s69, s80
  s_cbranch_scc1 gated_mix__ssm_conv_h3__grouped_kv_mqa__prompt_kernel_pl_wd_ok
  s_add_u32 s63, s63, 1
  s_cmp_gt_u32 s63, 1000000
  s_cbranch_scc1 gated_mix__ssm_conv_h3__grouped_kv_mqa__prompt_kernel_exit
  s_sleep 2
  s_branch gated_mix__ssm_conv_h3__grouped_kv_mqa__prompt_kernel_pl_wd
gated_mix__ssm_conv_h3__grouped_kv_mqa__prompt_kernel_pl_wd_ok:
gated_mix__ssm_conv_h3__grouped_kv_mqa__prompt_kernel_pl_nw:
  s_cmp_lg_u32 s84, 1
  s_cbranch_scc1 gated_mix__ssm_conv_h3__grouped_kv_mqa__prompt_kernel_pl_nk
  v_mov_b32 v4, 162092
  s_mov_b32 s63, 0
gated_mix__ssm_conv_h3__grouped_kv_mqa__prompt_kernel_plks:
  ds_read_b32 v12, v4
  s_waitcnt lgkmcnt(0)
  v_readfirstlane_b32 s69, v12
  s_nop 3
  s_cmp_ge_u32 s69, 3
  s_cbranch_scc1 gated_mix__ssm_conv_h3__grouped_kv_mqa__prompt_kernel_plks_ok
  s_add_u32 s63, s63, 1
  s_cmp_gt_u32 s63, 1000000
  s_cbranch_scc1 gated_mix__ssm_conv_h3__grouped_kv_mqa__prompt_kernel_exit
  s_branch gated_mix__ssm_conv_h3__grouped_kv_mqa__prompt_kernel_plks
gated_mix__ssm_conv_h3__grouped_kv_mqa__prompt_kernel_plks_ok:
gated_mix__ssm_conv_h3__grouped_kv_mqa__prompt_kernel_pl_nk:
  s_cmp_lg_u32 s84, 2
  s_cbranch_scc1 gated_mix__ssm_conv_h3__grouped_kv_mqa__prompt_kernel_pl_nq
  v_mov_b32 v4, 162068
  s_mov_b32 s63, 0
gated_mix__ssm_conv_h3__grouped_kv_mqa__prompt_kernel_plqm:
  ds_read_b32 v12, v4
  s_waitcnt lgkmcnt(0)
  v_readfirstlane_b32 s69, v12
  s_nop 3
  s_cmp_ge_u32 s69, 8
  s_cbranch_scc1 gated_mix__ssm_conv_h3__grouped_kv_mqa__prompt_kernel_plqm_ok
  s_add_u32 s63, s63, 1
  s_cmp_gt_u32 s63, 1000000
  s_cbranch_scc1 gated_mix__ssm_conv_h3__grouped_kv_mqa__prompt_kernel_exit
  s_branch gated_mix__ssm_conv_h3__grouped_kv_mqa__prompt_kernel_plqm
gated_mix__ssm_conv_h3__grouped_kv_mqa__prompt_kernel_plqm_ok:
gated_mix__ssm_conv_h3__grouped_kv_mqa__prompt_kernel_pl_nq:
  s_add_u32 s81, s75, s77
  s_and_b32 s81, s81, 7
  s_mul_i32 s81, s81, 21120
  s_add_u32 s81, s81, 32768
  s_add_u32 s83, s83, 1
  s_cmp_eq_u32 s83, 3
  s_cselect_b32 s83, 0, s83
  s_mov_b32 s82, 122880
  s_cmp_eq_u32 s83, 0
  s_cselect_b32 s82, 79872, s82
  s_cmp_eq_u32 s83, 2
  s_cselect_b32 s82, 101376, s82
  s_mov_b32 s60, s81
  s_mov_b32 m0, s82
  s_nop 0
  buffer_load_dwordx4 v9, s[16:19], s60 offen sc1 lds
  s_add_u32 s60, s60, 1024
  s_add_u32 m0, m0, 1024
  s_nop 0
  buffer_load_dwordx4 v9, s[16:19], s60 offen sc1 lds
  s_add_u32 s60, s60, 1024
  s_add_u32 m0, m0, 1024
  s_nop 0
  buffer_load_dwordx4 v9, s[16:19], s60 offen sc1 lds
  s_add_u32 s60, s60, 1024
  s_add_u32 m0, m0, 1024
  s_nop 0
  buffer_load_dwordx4 v9, s[16:19], s60 offen sc1 lds
  s_add_u32 s60, s60, 1024
  s_add_u32 m0, m0, 1024
  s_nop 0
  buffer_load_dwordx4 v9, s[16:19], s60 offen sc1 lds
  s_add_u32 s60, s60, 1024
  s_add_u32 m0, m0, 1024
  s_nop 0
  buffer_load_dwordx4 v9, s[16:19], s60 offen sc1 lds
  s_add_u32 s60, s60, 1024
  s_add_u32 m0, m0, 1024
  s_nop 0
  buffer_load_dwordx4 v9, s[16:19], s60 offen sc1 lds
  s_add_u32 s60, s60, 1024
  s_add_u32 m0, m0, 1024
  s_nop 0
  buffer_load_dwordx4 v9, s[16:19], s60 offen sc1 lds
  s_add_u32 s60, s60, 1024
  s_add_u32 m0, m0, 1024
  s_nop 0
  buffer_load_dwordx4 v9, s[16:19], s60 offen sc1 lds
  s_add_u32 s60, s60, 1024
  s_add_u32 m0, m0, 1024
  s_nop 0
  buffer_load_dwordx4 v9, s[16:19], s60 offen sc1 lds
  s_add_u32 s60, s60, 1024
  s_add_u32 m0, m0, 1024
  s_nop 0
  buffer_load_dwordx4 v9, s[16:19], s60 offen sc1 lds
  s_add_u32 s60, s60, 1024
  s_add_u32 m0, m0, 1024
  s_nop 0
  buffer_load_dwordx4 v9, s[16:19], s60 offen sc1 lds
  s_add_u32 s60, s60, 1024
  s_add_u32 m0, m0, 1024
  s_nop 0
  buffer_load_dwordx4 v9, s[16:19], s60 offen sc1 lds
  s_add_u32 s60, s60, 1024
  s_add_u32 m0, m0, 1024
  s_nop 0
  buffer_load_dwordx4 v9, s[16:19], s60 offen sc1 lds
  s_add_u32 s60, s60, 1024
  s_add_u32 m0, m0, 1024
  s_nop 0
  buffer_load_dwordx4 v9, s[16:19], s60 offen sc1 lds
  s_add_u32 s60, s60, 1024
  s_add_u32 m0, m0, 1024
  s_nop 0
  buffer_load_dwordx4 v9, s[16:19], s60 offen sc1 lds
  s_add_u32 s60, s60, 1024
  s_add_u32 m0, m0, 1024
  s_nop 0
  buffer_load_dwordx4 v9, s[16:19], s60 offen sc1 lds
  s_add_u32 s60, s60, 1024
  s_add_u32 m0, m0, 1024
  s_nop 0
  buffer_load_dwordx4 v9, s[16:19], s60 offen sc1 lds
  s_add_u32 s60, s60, 1024
  s_add_u32 m0, m0, 1024
  s_nop 0
  buffer_load_dwordx4 v9, s[16:19], s60 offen sc1 lds
  s_add_u32 s60, s60, 1024
  s_add_u32 m0, m0, 1024
  s_nop 0
  buffer_load_dwordx4 v9, s[16:19], s60 offen sc1 lds
  s_add_u32 s60, s60, 1024
  s_add_u32 m0, m0, 1024
  s_nop 0
  buffer_load_dwordx4 v9, s[16:19], s60 offen sc1 lds
  s_cmp_lg_u32 s78, 0
  s_cbranch_scc1 gated_mix__ssm_conv_h3__grouped_kv_mqa__prompt_kernel_pl_np
  s_cmp_ge_u32 s77, 7
  s_cbranch_scc1 gated_mix__ssm_conv_h3__grouped_kv_mqa__prompt_kernel_pl_np
  s_add_u32 s64, s75, s77
  s_add_u32 s64, s64, 1
  s_and_b32 s64, s64, 7
  s_lshl_b32 s64, s64, 7
  s_add_u32 s64, s64, s79
  s_mov_b64 exec, 0xffffffff
  buffer_load_dword v16, v10, s[16:19], s64 offen sc1
  s_mov_b64 exec, -1
  s_waitcnt vmcnt(0)
  s_add_u32 s84, s84, 1
  v_mov_b32 v4, 161880
  v_mov_b32 v12, s84
  s_mov_b64 exec, 1
  ds_write_b32 v4, v12
  s_mov_b64 exec, -1
  s_mov_b64 exec, 0xffffffff
  v_cmp_ne_u32 vcc, s98, v16
  s_mov_b64 exec, -1
  s_nop 4
  s_cmp_eq_u64 vcc, 0
  s_cbranch_scc1 gated_mix__ssm_conv_h3__grouped_kv_mqa__prompt_kernel_pl_go
  s_mov_b32 s63, 0
  s_mov_b64 exec, 0xffffffff
gated_mix__ssm_conv_h3__grouped_kv_mqa__prompt_kernel_pb_again:
  buffer_load_dword v16, v10, s[16:19], s64 offen sc1
  s_waitcnt vmcnt(0)
  v_cmp_ne_u32 vcc, s98, v16
  s_nop 4
  s_cmp_eq_u64 vcc, 0
  s_cbranch_scc1 gated_mix__ssm_conv_h3__grouped_kv_mqa__prompt_kernel_pb_ok
  s_sleep 1
  s_add_u32 s63, s63, 1
  s_cmp_gt_u32 s63, 100000
  s_cbranch_scc1 gated_mix__ssm_conv_h3__grouped_kv_mqa__prompt_kernel_exit
  s_branch gated_mix__ssm_conv_h3__grouped_kv_mqa__prompt_kernel_pb_again
gated_mix__ssm_conv_h3__grouped_kv_mqa__prompt_kernel_pb_ok:
  s_mov_b64 exec, -1
  s_branch gated_mix__ssm_conv_h3__grouped_kv_mqa__prompt_kernel_pl_go
gated_mix__ssm_conv_h3__grouped_kv_mqa__prompt_kernel_pl_np:
  s_waitcnt vmcnt(0)
  s_add_u32 s84, s84, 1
  v_mov_b32 v4, 161880
  v_mov_b32 v12, s84
  s_mov_b64 exec, 1
  ds_write_b32 v4, v12
  s_mov_b64 exec, -1
gated_mix__ssm_conv_h3__grouped_kv_mqa__prompt_kernel_pl_go:
  s_cmp_lg_u32 s84, 1
  s_cbranch_scc1 gated_mix__ssm_conv_h3__grouped_kv_mqa__prompt_kernel_nost1
gated_mix__ssm_conv_h3__grouped_kv_mqa__prompt_kernel_nost1:
  s_cmp_lg_u32 s77, 3
  s_cbranch_scc1 gated_mix__ssm_conv_h3__grouped_kv_mqa__prompt_kernel_nowarm
  s_cmp_lg_u32 s78, 0
  s_cbranch_scc1 gated_mix__ssm_conv_h3__grouped_kv_mqa__prompt_kernel_nowarm
  v_lshrrev_b32 v16, 1, v1
  v_mul_u32_u24 v16, 1280, v16
  v_and_b32 v17, 1, v1
  v_lshl_add_u32 v16, v17, 7, v16
  s_mul_i32 s60, s57, 160
  s_and_b32 s60, s60, 0xffffff80
  s_add_u32 s60, s60, 532480
  buffer_load_dword v18, v16, s[36:39], s60 offen
  s_add_u32 s60, s60, 40960
  buffer_load_dword v18, v16, s[36:39], s60 offen
  s_add_u32 s60, s60, 40960
  buffer_load_dword v18, v16, s[36:39], s60 offen
  s_add_u32 s60, s60, 40960
  buffer_load_dword v18, v16, s[36:39], s60 offen
  s_add_u32 s60, s60, 40960
  buffer_load_dword v18, v16, s[36:39], s60 offen
  s_add_u32 s60, s60, 40960
  buffer_load_dword v18, v16, s[36:39], s60 offen
  s_add_u32 s60, s60, 40960
  buffer_load_dword v18, v16, s[36:39], s60 offen
gated_mix__ssm_conv_h3__grouped_kv_mqa__prompt_kernel_nowarm:
  s_cmp_lt_u32 s77, 2
  s_cbranch_scc1 gated_mix__ssm_conv_h3__grouped_kv_mqa__prompt_kernel_lm_noc
  s_add_u32 s70, s71, 4
  s_min_u32 s70, s70, 26
gated_mix__ssm_conv_h3__grouped_kv_mqa__prompt_kernel_woa_l:
  s_cmp_ge_u32 s71, s70
  s_cbranch_scc1 gated_mix__ssm_conv_h3__grouped_kv_mqa__prompt_kernel_woa_e
  s_mul_i32 s60, s71, 20480
  s_mul_i32 s61, s71, 3072
  s_mov_b32 m0, s61
  s_nop 0
  buffer_load_dwordx4 v5, s[36:39], s60 offen lds
  s_add_u32 m0, s61, 1024
  s_nop 0
  buffer_load_dwordx4 v6, s[36:39], s60 offen lds
  s_add_u32 m0, s61, 2048
  s_nop 0
  buffer_load_dwordx4 v7, s[36:39], s60 offen lds
  s_add_u32 s71, s71, 1
  s_branch gated_mix__ssm_conv_h3__grouped_kv_mqa__prompt_kernel_woa_l
gated_mix__ssm_conv_h3__grouped_kv_mqa__prompt_kernel_woa_e:
gated_mix__ssm_conv_h3__grouped_kv_mqa__prompt_kernel_lm_noc:
  s_add_u32 s77, s77, 1
  s_cmp_lt_u32 s77, 8
  s_cbranch_scc1 gated_mix__ssm_conv_h3__grouped_kv_mqa__prompt_kernel_pl
  s_cmp_lg_u32 s78, 0
  s_cbranch_scc1 gated_mix__ssm_conv_h3__grouped_kv_mqa__prompt_kernel_pl_later
  v_lshlrev_b32 v11, 3, v1
  s_mov_b32 s60, 202752
  buffer_load_dwordx2 v[12:13], v11, s[16:19], s60 offen sc1
  buffer_load_dwordx2 v[14:15], v11, s[16:19], s60 offen offset:512 sc1
  s_lshr_b32 s60, s56, 2
  s_and_b32 s61, s56, 3
  s_lshl_b32 s61, s61, 3
  s_add_u32 s60, s60, s61
  s_lshl_b32 s60, s60, 2
  s_add_u32 s60, s60, 19456
  v_and_b32 v18, 7, v1
  v_lshlrev_b32 v18, 7, v18
  buffer_load_dword v19, v18, s[16:19], s60 offen sc1
  s_cmp_lg_u32 s2, 0
  s_cbranch_scc1 gated_mix__ssm_conv_h3__grouped_kv_mqa__prompt_kernel_noep
  v_mov_b32 v16, 0
  v_mov_b32 v17, s98
  s_mov_b64 exec, 1
  buffer_store_dword v17, v16, s[16:19], 0 offen
  s_mov_b64 exec, -1
gated_mix__ssm_conv_h3__grouped_kv_mqa__prompt_kernel_noep:
  v_mov_b32 v4, 162068
  s_mov_b32 s63, 0
gated_mix__ssm_conv_h3__grouped_kv_mqa__prompt_kernel_lqm:
  ds_read_b32 v20, v4
  s_waitcnt lgkmcnt(0)
  v_readfirstlane_b32 s69, v20
  s_nop 3
  s_cmp_ge_u32 s69, 8
  s_cbranch_scc1 gated_mix__ssm_conv_h3__grouped_kv_mqa__prompt_kernel_lqm_ok
  s_add_u32 s63, s63, 1
  s_cmp_gt_u32 s63, 1000000
  s_cbranch_scc1 gated_mix__ssm_conv_h3__grouped_kv_mqa__prompt_kernel_exit
  s_branch gated_mix__ssm_conv_h3__grouped_kv_mqa__prompt_kernel_lqm
gated_mix__ssm_conv_h3__grouped_kv_mqa__prompt_kernel_lqm_ok:
  v_mov_b32 v4, 161856
  ds_read_b32 v20, v4
  s_waitcnt vmcnt(0) lgkmcnt(0)
  v_max_f32 v12, v12, v13
  v_mul_f32 v12, v12, v20
  v_max_f32 v14, v14, v15
  s_mov_b32 s60, 0x45100000
  s_mov_b32 s61, 0x5d800000
  v_cmp_nge_f32 vcc, s60, v12
  v_cmp_nge_f32 s[64:65], s61, v14
  s_nop 4
  s_or_b64 s[64:65], s[64:65], vcc
  s_cmp_lg_u64 s[64:65], 0
  s_cselect_b32 s80, 1, 0
  s_getreg_b32 s60, hwreg(HW_REG_XCC_ID)
  s_and_b32 s60, s60, 15
  v_cmp_ne_u32 vcc, s60, v19
  s_nop 4
  s_cmp_eq_u64 vcc, 0
  s_cselect_b32 s60, 1, 0
  v_mov_b32 v4, 161968
  v_mov_b32 v19, s60
  ds_write_b32 v4, v19
  v_mov_b32 v4, 161972
  v_mov_b32 v19, s80
  ds_write_b32 v4, v19 offset:4
  v_mov_b32 v19, 1
  s_waitcnt lgkmcnt(0)
  ds_write_b32 v4, v19
  s_cmp_eq_u32 s80, 0
  s_cbranch_scc1 gated_mix__ssm_conv_h3__grouped_kv_mqa__prompt_kernel_pl_end
gated_mix__ssm_conv_h3__grouped_kv_mqa__prompt_kernel_pl_later:
  s_cmp_eq_u32 s78, 2
  s_cbranch_scc1 gated_mix__ssm_conv_h3__grouped_kv_mqa__prompt_kernel_pl_end
  s_add_u32 s78, s78, 1
  s_add_u32 s76, s76, 72
  s_mov_b32 s63, 0
  v_mov_b32 v4, 161884
gated_mix__ssm_conv_h3__grouped_kv_mqa__prompt_kernel_pl_nx:
  ds_read_b32 v12, v4
  s_waitcnt lgkmcnt(0)
  v_readfirstlane_b32 s69, v12
  s_nop 3
  s_cmp_ge_u32 s69, s76
  s_cbranch_scc1 gated_mix__ssm_conv_h3__grouped_kv_mqa__prompt_kernel_pl_nx_ok
  s_add_u32 s63, s63, 1
  s_cmp_gt_u32 s63, 1000000
  s_cbranch_scc1 gated_mix__ssm_conv_h3__grouped_kv_mqa__prompt_kernel_exit
  s_sleep 2
  s_branch gated_mix__ssm_conv_h3__grouped_kv_mqa__prompt_kernel_pl_nx
gated_mix__ssm_conv_h3__grouped_kv_mqa__prompt_kernel_pl_nx_ok:
  s_branch gated_mix__ssm_conv_h3__grouped_kv_mqa__prompt_kernel_pass
gated_mix__ssm_conv_h3__grouped_kv_mqa__prompt_kernel_pl_end:
  s_mov_b32 s70, 26
gated_mix__ssm_conv_h3__grouped_kv_mqa__prompt_kernel_woz_l:
  s_cmp_ge_u32 s71, s70
  s_cbranch_scc1 gated_mix__ssm_conv_h3__grouped_kv_mqa__prompt_kernel_woz_e
  s_mul_i32 s60, s71, 20480
  s_mul_i32 s61, s71, 3072
  s_mov_b32 m0, s61
  s_nop 0
  buffer_load_dwordx4 v5, s[36:39], s60 offen lds
  s_add_u32 m0, s61, 1024
  s_nop 0
  buffer_load_dwordx4 v6, s[36:39], s60 offen lds
  s_add_u32 m0, s61, 2048
  s_nop 0
  buffer_load_dwordx4 v7, s[36:39], s60 offen lds
  s_add_u32 s71, s71, 1
  s_branch gated_mix__ssm_conv_h3__grouped_kv_mqa__prompt_kernel_woz_l
gated_mix__ssm_conv_h3__grouped_kv_mqa__prompt_kernel_woz_e:
  s_waitcnt vmcnt(0)
  v_mov_b32 v4, 162080
  v_mov_b32 v12, 1
  s_mov_b64 exec, 1
  ds_add_u32 v4, v12
  s_mov_b64 exec, -1
  v_lshlrev_b32 v11, 2, v1
  s_lshl_b32 s64, s56, 8
  s_add_u32 s64, s64, 11264
  s_mov_b32 s63, 0
  s_mov_b64 exec, -1
gated_mix__ssm_conv_h3__grouped_kv_mqa__prompt_kernel_pf_again:
  buffer_load_dword v12, v11, s[16:19], s64 offen sc1
  s_waitcnt vmcnt(0)
  v_cmp_ne_u32 vcc, s98, v12
  s_nop 4
  s_cmp_eq_u64 vcc, 0
  s_cbranch_scc1 gated_mix__ssm_conv_h3__grouped_kv_mqa__prompt_kernel_pf_ok
  s_sleep 1
  s_add_u32 s63, s63, 1
  s_cmp_gt_u32 s63, 100000
  s_cbranch_scc1 gated_mix__ssm_conv_h3__grouped_kv_mqa__prompt_kernel_exit
  s_branch gated_mix__ssm_conv_h3__grouped_kv_mqa__prompt_kernel_pf_again
gated_mix__ssm_conv_h3__grouped_kv_mqa__prompt_kernel_pf_ok:
  s_mov_b64 exec, -1
  v_mov_b32 v4, 161960
  v_mov_b32 v12, 1
  s_mov_b64 exec, 1
  ds_add_u32 v4, v12
  s_mov_b64 exec, -1
  v_mov_b32 v4, 161952
  s_mov_b32 s63, 0
gated_mix__ssm_conv_h3__grouped_kv_mqa__prompt_kernel_lend:
  ds_read_b32 v12, v4
  s_waitcnt lgkmcnt(0)
  v_readfirstlane_b32 s69, v12
  s_nop 3
  s_cmp_ge_u32 s69, 8
  s_cbranch_scc1 gated_mix__ssm_conv_h3__grouped_kv_mqa__prompt_kernel_lend_ok
  s_add_u32 s63, s63, 1
  s_cmp_gt_u32 s63, 1000000
  s_cbranch_scc1 gated_mix__ssm_conv_h3__grouped_kv_mqa__prompt_kernel_exit
  s_branch gated_mix__ssm_conv_h3__grouped_kv_mqa__prompt_kernel_lend
gated_mix__ssm_conv_h3__grouped_kv_mqa__prompt_kernel_lend_ok:
  s_lshl_b32 s64, s57, 7
  s_add_u32 s64, s64, 10240
  s_mov_b32 s63, 0
  s_mov_b64 exec, 0xffffffff
gated_mix__ssm_conv_h3__grouped_kv_mqa__prompt_kernel_py_again:
  buffer_load_dword v12, v11, s[16:19], s64 offen sc1
  s_waitcnt vmcnt(0)
  v_cmp_ne_u32 vcc, s98, v12
  s_nop 4
  s_cmp_eq_u64 vcc, 0
  s_cbranch_scc1 gated_mix__ssm_conv_h3__grouped_kv_mqa__prompt_kernel_py_ok
  s_sleep 1
  s_add_u32 s63, s63, 1
  s_cmp_gt_u32 s63, 100000
  s_cbranch_scc1 gated_mix__ssm_conv_h3__grouped_kv_mqa__prompt_kernel_exit
  s_branch gated_mix__ssm_conv_h3__grouped_kv_mqa__prompt_kernel_py_again
gated_mix__ssm_conv_h3__grouped_kv_mqa__prompt_kernel_py_ok:
  s_mov_b64 exec, -1
  v_lshrrev_b32 v13, 3, v1
  v_lshlrev_b32 v13, 12, v13
  v_and_b32 v14, 7, v1
  v_lshl_add_u32 v13, v14, 4, v13
  s_mul_i32 s60, s57, 327680
  s_lshl_b32 s61, s56, 7
  s_add_u32 s60, s60, s61
  s_add_u32 s60, s60, 5454848
  s_mov_b32 m0, 122880
  s_nop 0
  buffer_load_dwordx4 v13, s[16:19], s60 offen sc1 lds
  s_add_u32 s60, s60, 32768
  s_add_u32 m0, m0, 1024
  s_nop 0
  buffer_load_dwordx4 v13, s[16:19], s60 offen sc1 lds
  s_add_u32 s60, s60, 32768
  s_add_u32 m0, m0, 1024
  s_nop 0
  buffer_load_dwordx4 v13, s[16:19], s60 offen sc1 lds
  s_add_u32 s60, s60, 32768
  s_add_u32 m0, m0, 1024
  s_nop 0
  buffer_load_dwordx4 v13, s[16:19], s60 offen sc1 lds
  s_add_u32 s60, s60, 32768
  s_add_u32 m0, m0, 1024
  s_nop 0
  buffer_load_dwordx4 v13, s[16:19], s60 offen sc1 lds
  s_add_u32 s60, s60, 32768
  s_add_u32 m0, m0, 1024
  s_nop 0
  buffer_load_dwordx4 v13, s[16:19], s60 offen sc1 lds
  s_add_u32 s60, s60, 32768
  s_add_u32 m0, m0, 1024
  s_nop 0
  buffer_load_dwordx4 v13, s[16:19], s60 offen sc1 lds
  s_add_u32 s60, s60, 32768
  s_add_u32 m0, m0, 1024
  s_nop 0
  buffer_load_dwordx4 v13, s[16:19], s60 offen sc1 lds
  s_add_u32 s60, s60, 32768
  s_add_u32 m0, m0, 1024
  s_nop 0
  buffer_load_dwordx4 v13, s[16:19], s60 offen sc1 lds
  s_add_u32 s60, s60, 32768
  s_add_u32 m0, m0, 1024
  s_nop 0
  buffer_load_dwordx4 v13, s[16:19], s60 offen sc1 lds
  s_waitcnt vmcnt(0)
  v_mov_b32 v4, 161964
  v_mov_b32 v12, 1
  s_mov_b64 exec, 1
  ds_add_u32 v4, v12
  s_mov_b64 exec, -1
  s_waitcnt lgkmcnt(0)
gated_mix__ssm_conv_h3__grouped_kv_mqa__prompt_kernel_exit:
  s_endpgm
gated_mix__ssm_conv_h3__grouped_kv_mqa__prompt_kernel_end:
  s_endpgm
.section .rodata,"a"
.p2align 6
.amdhsa_kernel gated_mix__ssm_conv_h3__grouped_kv_mqa__prompt_kernel
  .amdhsa_next_free_vgpr 168
  .amdhsa_next_free_sgpr 102
  .amdhsa_accum_offset 168
  .amdhsa_group_segment_fixed_size 0
  .amdhsa_kernarg_size 120
  .amdhsa_user_sgpr_count 2
  .amdhsa_user_sgpr_kernarg_segment_ptr 1
  .amdhsa_system_sgpr_workgroup_id_x 1
.end_amdhsa_kernel
```
